```python
import torch

def _softmax(x, axis=-1):
    return torch.softmax(x, dim=axis)
def _gelu(x):
    return torch.nn.functional.gelu(x, approximate="tanh")
def _silu(x):
    return torch.nn.functional.silu(x)
def _sigmoid(x):
    return torch.sigmoid(x)
def _layernorm(x, axis=-1, eps=1e-5):
    m = x.mean(dim=axis, keepdim=True)
    v = x.var(dim=axis, keepdim=True, unbiased=False)
    return (x - m) / torch.sqrt(v + eps)
def _scatter_add(tgt, idx, src, axis=0):
    return tgt.clone().index_add_(axis, idx, src)
def _segment_sum(src, seg, n):
    out = torch.zeros((n,) + src.shape[1:], dtype=src.dtype)
    return out.index_add_(0, seg, src)
def _pad(x, pw):
    flat = tuple(v for pair in reversed(pw) for v in pair)
    return torch.nn.functional.pad(x, flat)

kernel_name = 'gated_mix__softmax_full_mha__geglu_ffn__prompt'

def setup_inputs():

    _w = (lambda a: (lambda t: t.to(torch.bfloat16) if t.is_floating_point() else t)(torch.as_tensor(a)))
    def _A_setup():
        B, S, D = 1, 2048, 512
        return {
            "x": _w((lambda *s: torch.randn(*s, dtype=torch.bfloat16) * 0.05)(B, S, D)),
            "wqkv": _w((lambda *s: torch.randn(*s, dtype=torch.bfloat16) * 0.8)(D, 3 * D)),
            "wo": _w((lambda *s: torch.randn(*s, dtype=torch.bfloat16) * 0.05)(D, D)),
        }
    _A_in = _A_setup()

    def _B_setup():
        B, S, D, F = 1, 2048, 512, 1792
        return {
            "x": _w((lambda *s: torch.randn(*s, dtype=torch.bfloat16) * 0.05)(B, S, D)),
            "w_gate": _w((lambda *s: torch.randn(*s, dtype=torch.bfloat16) * 0.1)(D, F)),
            "w_up": _w((lambda *s: torch.randn(*s, dtype=torch.bfloat16) * 0.1)(D, F)),
            "w_down": _w((lambda *s: torch.randn(*s, dtype=torch.bfloat16) * 0.1)(F, D)),
        }
    _B_in = _B_setup()

    return {
        "A_x": _A_in["x"],
        "A_wqkv": _A_in["wqkv"],
        "A_wo": _A_in["wo"],
        "B_x": _B_in["x"],
        "B_w_gate": _B_in["w_gate"],
        "B_w_up": _B_in["w_up"],
        "B_w_down": _B_in["w_down"],
        "gate_w": _w((lambda *s: torch.randn(*s, dtype=torch.bfloat16) * 0.05)(512) * 16.0),
    }

def reference(A_x, A_wqkv, A_wo, B_x, B_w_gate, B_w_up, B_w_down, gate_w):
    def _A_ref(x, wqkv, wo):
        B, S, D = x.shape
        H = 32; Dh = D // H
        qkv = (lambda x, *d: x.permute(*d))((x @ wqkv).reshape(B, S, 3, H, Dh), 2, 0, 3, 1, 4)
        q, k, v = qkv[0], qkv[1], qkv[2]
        scale = Dh ** -0.5
        scores = torch.einsum("bhqd,bhkd->bhqk", q, k) * scale
        p = _softmax(scores, axis=-1)
        o = torch.einsum("bhqk,bhkd->bhqd", p, v)
        return (lambda x, *d: x.permute(*d))(o, 0, 2, 1, 3).reshape(B, S, D) @ wo

    def _B_ref(x, w_gate, w_up, w_down):
        return (_gelu(x @ w_gate) * (x @ w_up)) @ w_down

    x = A_x
    g = _sigmoid((x * gate_w).sum(-1, keepdims=True))
    a = _A_ref(x, A_wqkv, A_wo)
    b = _B_ref(x, B_w_gate, B_w_up, B_w_down)
    return g * a + (1 - g) * b
```

```asm
; @launch grid=(256,1,1) block=(512,1,1) lds=163840
.amdgcn_target "amdgcn-amd-amdhsa--gfx950"
.text
.globl gated_mix__softmax_full_mha__geglu_ffn__prompt_kernel
.p2align 8
.type gated_mix__softmax_full_mha__geglu_ffn__prompt_kernel,@function
gated_mix__softmax_full_mha__geglu_ffn__prompt_kernel:
    s_load_dwordx16 s[76:91], s[0:1], 0
    s_load_dwordx2 s[4:5], s[0:1], 80
    s_load_dwordx4 s[92:95], s[0:1], 64
    s_getpc_b64 s[40:41]
L_pc:
    v_lshlrev_b32 v4, 7, v0
    v_min_u32 v4, L_end-L_pc, v4
    global_load_dword v8, v4, s[40:41]
    s_cmp_ge_u32 s2, 256
    s_cbranch_scc1 L_end
    v_lshrrev_b32 v2, 6, v0
    v_and_b32 v1, 63, v0
    s_bfe_u32 s9, s2, 0x20001
    v_readfirstlane_b32 s8, v2
    s_lshr_b32 s10, s2, 6
    s_mul_i32 s53, s9, 3
    s_add_u32 s53, s53, s10
    s_add_u32 s9, s9, 13
    s_cmp_eq_u32 s10, 0
    s_cselect_b32 s53, s9, s53
    s_sub_u32 s53, s53, 1
    s_and_b32 s9, s2, 1
    s_lshl_b32 s52, s9, 3
    s_bfe_u32 s9, s2, 0x30003
    s_add_u32 s52, s52, s9
    s_and_b32 s3, s8, 3
    v_and_b32 v2, 3, v2
    s_and_b32 s64, s2, 6
    s_or_b32 s64, s64, 1
    s_and_b32 s9, s9, 6
    s_and_b32 s10, s2, 1
    s_add_u32 s9, s9, s10
    s_cmp_lt_u32 s8, 4
    s_cbranch_scc1 L_attn
    s_cmp_ge_u32 s53, 12
    s_cselect_b32 s38, 6, 7
    s_cselect_b32 s11, 0x80, 0
    s_cselect_b32 s10, 8, 7
    s_cselect_b32 s39, -4, 16
    s_add_u32 s39, s39, s53
    s_lshl_b32 s39, s39, s10
    s_lshl_b32 s18, s38, 18
    s_mov_b32 s22, s18
    s_mov_b32 s14, 0x200000
    s_mov_b32 s26, 0x180000
    s_mov_b32 s15, 0x20000
    s_mov_b32 s19, 0x20000
    s_mov_b32 s23, 0x20000
    s_mov_b32 s27, 0x20000
    s_lshl_b32 s36, s9, 1
    s_lshl_b32 s40, s52, 17
    s_lshl_b32 s51, s53, 7
    s_lshl_b32 s9, s38, 9
    s_lshl_b32 s38, s38, 14
    v_lshrrev_b32 v4, 3, v1
    v_lshl_add_u32 v5, v2, 4, v4
    v_lshlrev_b32 v12, 10, v5
    v_lshl_add_u32 v4, v2, 3, v4
    v_mul_u32_u24 v14, s9, v4
    v_mul_u32_u24 v16, 3072, v4
    v_mul_u32_u24 v17, 3584, v4
    v_lshrrev_b32 v4, 4, v1
    v_xor_b32 v5, v4, v1
    v_and_b32 v5, 7, v5
    v_lshl_add_u32 v12, v5, 4, v12
    v_xor_b32 v13, 64, v12
    v_add_u32 v13, 7168, v13
    v_and_b32 v4, 1, v4
    v_lshlrev_b32 v5, 2, v4
    v_xor_b32 v5, v5, v1
    v_and_b32 v5, 7, v5
    v_lshl_add_u32 v16, v5, 4, v16
    v_lshlrev_b32 v5, 1, v4
    v_xor_b32 v5, v5, v1
    v_and_b32 v5, 7, v5
    v_lshl_add_u32 v14, v5, 4, v14
    v_lshl_add_u32 v17, v5, 4, v17
    v_xor_b32 v15, 64, v14
    v_add_u32 v15, s11, v15
    v_xor_b32 v18, 64, v17
    s_lshl_b32 s42, s3, 10
    s_add_u32 s42, s42, 16384
    s_mov_b32 s41, s42
    s_lshl_b32 s43, s3, 11
    s_add_u32 s43, s43, 65536
    s_mov_b32 s37, 0
    s_lshl_b32 s65, s64, 1
    s_sub_u32 s65, s65, 1
    s_xor_b32 s66, s65, 1
    s_mov_b32 s67, s65
    s_cmp_ge_u32 s53, 12
    s_waitcnt lgkmcnt(0)
    s_mov_b64 s[12:13], s[76:77]
    s_mov_b64 s[24:25], s[78:79]
    s_cselect_b64 s[16:17], s[78:79], s[84:85]
    s_cselect_b64 s[20:21], s[78:79], s[86:87]
    s_bfe_u32 s9, s36, 0x30001
    s_lshl_b32 s9, s9, 7
    s_and_b32 s10, s37, 1
    s_lshl_b32 s10, s10, 16
    s_add_u32 s9, s9, s10
    s_add_u32 s9, s9, s40
    s_cmp_ge_u32 s37, 12
    s_cselect_b32 s10, 12, 0
    s_sub_u32 s10, s37, s10
    s_lshl_b32 s10, s10, 13
    s_add_u32 s10, s10, s43
    s_cmp_lt_u32 s37, 16
    s_cselect_b32 m0, s10, 196608
    s_cselect_b32 s9, s9, 1073741824
    buffer_load_dwordx4 v12, s[12:15], s9 offen lds
    buffer_load_dwordx4 v13, s[12:15], s9 offen offset:1024 lds
Dp_pro:
    s_and_b32 s9, s36, 15
    s_mul_i32 s10, s9, s38
    s_mov_b32 m0, s41
    s_add_u32 s10, s10, s39
    buffer_load_dwordx4 v14, s[16:19], s10 offen lds
    s_add_u32 m0, s41, 4096
    s_mul_i32 s9, s9, 98304
    buffer_load_dwordx4 v15, s[20:23], s10 offen lds
    s_add_u32 m0, s41, 8192
    s_add_u32 s9, s9, s51
    buffer_load_dwordx4 v16, s[24:27], s9 offen lds
    s_xor_b32 s67, s67, s66
    s_add_u32 s36, s36, s67
    s_add_u32 s37, s37, 1
    s_add_u32 s41, s41, 12288
    s_cmp_ge_u32 s41, 65536
    s_cselect_b32 s41, s42, s41
    s_bfe_u32 s9, s36, 0x30001
    s_lshl_b32 s9, s9, 7
    s_and_b32 s10, s37, 1
    s_lshl_b32 s10, s10, 16
    s_add_u32 s9, s9, s10
    s_add_u32 s9, s9, s40
    s_cmp_ge_u32 s37, 12
    s_cselect_b32 s10, 12, 0
    s_sub_u32 s10, s37, s10
    s_lshl_b32 s10, s10, 13
    s_add_u32 s10, s10, s43
    s_cmp_lt_u32 s37, 16
    s_cselect_b32 m0, s10, 196608
    s_cselect_b32 s9, s9, 1073741824
    buffer_load_dwordx4 v12, s[12:15], s9 offen lds
    buffer_load_dwordx4 v13, s[12:15], s9 offen offset:1024 lds
    s_cmp_lt_u32 s37, 3
    s_cbranch_scc1 Dp_pro
    s_mov_b64 s[28:29], s[90:91]
    s_mov_b32 s30, 0x400
    s_mov_b32 s31, 0x20000
    s_mov_b32 s6, 0x1000000
    s_mov_b32 s7, 0x20000
    s_mov_b32 s46, 256
    s_mov_b32 s47, 0x20000
    v_lshlrev_b32 v3, 4, v1
    s_lshl_b32 s54, s52, 4
    s_add_u32 s54, s54, s53
    s_lshl_b32 s54, s54, 7
    s_and_b32 s9, s2, 7
    s_lshl_b32 s55, s9, 2
    s_bfe_u32 s9, s2, 0x20003
    s_add_u32 s55, s55, s9
    s_lshl_b32 s55, s55, 17
    s_add_u32 s55, s55, 2097152
    s_lshl_b32 s56, s3, 12
    v_add_u32 v10, s56, v3
    s_add_u32 s54, s54, 15826944
    s_mov_b64 s[44:45], s[94:95]
    s_lshl_b32 s9, s52, 4
    s_add_u32 s9, s9, s53
    s_lshl_b32 s9, s9, 2
    s_add_u32 s9, s9, s3
    s_lshl_b32 s59, s9, 3
    s_add_u32 s59, s59, 15728640
    s_lshl_b32 s61, s9, 11
    s_mov_b64 s[32:33], s[86:87]
    s_mov_b32 s34, 0x1c0000
    s_mov_b32 s35, 0x20000
    v_mov_b64 v[184:185], 0
    v_mov_b64 v[186:187], 0
    v_mov_b64 v[188:189], 0
    v_mov_b64 v[190:191], 0
    v_mov_b32 v11, 0
    s_nop 1
    v_mfma_f32_32x32x16_bf16 v[104:119], v[184:187], v[184:187], 0
    v_mfma_f32_32x32x16_bf16 v[120:135], v[184:187], v[184:187], 0
    v_mfma_f32_32x32x16_bf16 v[136:151], v[184:187], v[184:187], 0
    v_mfma_f32_32x32x16_bf16 v[152:167], v[184:187], v[184:187], 0
    v_mfma_f32_32x32x16_bf16 v[40:55], v[184:187], v[184:187], 0
    v_mfma_f32_32x32x16_bf16 v[56:71], v[184:187], v[184:187], 0
    v_mfma_f32_32x32x16_bf16 v[72:87], v[184:187], v[184:187], 0
    v_mfma_f32_32x32x16_bf16 v[88:103], v[184:187], v[184:187], 0
    v_mfma_f32_32x32x16_bf16 v[20:35], v[184:187], v[184:187], 0
    s_waitcnt lgkmcnt(0)
    s_branch Dp_l1
L_attn:
    s_and_b32 s62, s9, 7
    s_lshl_b32 s62, s62, 7
    s_mul_i32 s10, s64, 5
    s_add_u32 s9, s9, s10
    s_lshl_b32 s9, s9, 1
    s_add_u32 s9, s9, 1
    s_and_b32 s9, s9, 15
    s_lshl_b32 s65, s64, 1
    s_sub_u32 s65, s65, 1
    s_mul_i32 s65, s65, 114688
    s_lshl_b32 s64, s64, 7
    s_lshl_b32 s63, s53, 7
    s_mul_i32 s59, s9, 114688
    s_add_u32 s59, s59, s63
    s_add_u32 s61, s63, 1835008
    s_lshl_b32 s51, s52, 17
    s_lshl_b32 s18, s3, 10
    s_add_u32 s18, s18, 16384
    s_lshl_b32 s19, s3, 11
    s_add_u32 s19, s19, 65536
    s_mov_b32 s6, 0x1000000
    s_mov_b32 s7, 0x20000
    s_mov_b32 s46, 256
    s_mov_b32 s47, 0x20000
    v_lshlrev_b32 v3, 4, v1
    s_lshl_b32 s54, s52, 4
    s_add_u32 s54, s54, s53
    s_lshl_b32 s54, s54, 7
    s_and_b32 s9, s2, 7
    s_lshl_b32 s55, s9, 2
    s_bfe_u32 s9, s2, 0x20003
    s_add_u32 s55, s55, s9
    s_lshl_b32 s55, s55, 17
    s_add_u32 s55, s55, 2097152
    s_lshl_b32 s56, s3, 12
    v_add_u32 v10, s56, v3
    s_add_u32 s54, s54, 15794176
    v_mov_b64 v[76:77], 0
    v_mov_b64 v[78:79], 0
    s_nop 1
    v_mfma_f32_32x32x16_bf16 v[104:119], v[76:79], v[76:79], 0
    v_mfma_f32_32x32x16_bf16 v[120:135], v[76:79], v[76:79], 0
    v_mfma_f32_32x32x16_bf16 v[136:151], v[76:79], v[76:79], 0
    v_mfma_f32_32x32x16_bf16 v[152:167], v[76:79], v[76:79], 0
    v_mfma_f32_32x32x16_bf16 v[168:183], v[76:79], v[76:79], 0
    v_mfma_f32_32x32x16_bf16 v[184:199], v[76:79], v[76:79], 0
    v_and_b32 v4, 31, v1
    v_lshlrev_b32 v12, 7, v4
    v_bfe_u32 v4, v1, 1, 3
    v_lshrrev_b32 v5, 5, v1
    v_xor_b32 v4, v4, v5
    v_lshl_add_u32 v12, v4, 4, v12
    s_and_b32 s9, s3, 1
    s_lshl_b32 s9, s9, 13
    s_add_u32 s9, s9, 65536
    v_add_u32 v12, s9, v12
    v_xor_b32 v13, 32, v12
    v_xor_b32 v14, 64, v12
    v_xor_b32 v15, 96, v12
    v_lshrrev_b32 v4, 5, v1
    v_mul_u32_u24 v16, 1024, v4
    v_bfe_u32 v4, v1, 2, 2
    v_mul_u32_u24 v4, 128, v4
    v_bfe_u32 v5, v1, 4, 1
    v_mul_u32_u24 v5, 4096, v5
    v_add3_u32 v16, v16, v4, v5
    v_and_b32 v4, 1, v1
    v_and_b32 v5, 2, v1
    v_lshl_add_u32 v16, v4, 4, v16
    v_lshl_add_u32 v16, v5, 2, v16
    v_bfe_u32 v4, v1, 3, 2
    v_and_b32 v5, 2, v2
    v_xor_b32 v4, v4, v5
    v_lshl_add_u32 v16, v4, 5, v16
    v_add_u32 v16, 16384, v16
    v_xor_b32 v17, 32, v16
    v_lshrrev_b32 v4, 5, v1
    v_mul_u32_u24 v18, 1024, v4
    v_bfe_u32 v4, v1, 2, 2
    v_mul_u32_u24 v4, 128, v4
    v_bfe_u32 v5, v1, 4, 1
    v_mul_u32_u24 v5, 32, v5
    v_add3_u32 v18, v18, v4, v5
    v_and_b32 v4, 1, v1
    v_and_b32 v5, 2, v1
    v_lshl_add_u32 v18, v4, 4, v18
    v_lshl_add_u32 v18, v5, 2, v18
    v_lshrrev_b32 v4, 3, v1
    v_lshrrev_b32 v5, 1, v2
    v_xor_b32 v4, v4, v5
    v_and_b32 v4, 1, v4
    v_lshl_add_u32 v18, v4, 6, v18
    v_add_u32 v18, 24576, v18
    s_and_b32 s9, s2, 7
    s_lshr_b32 s10, s2, 5
    v_and_b32 v4, 1, v1
    v_and_b32 v5, 1, v1
    v_lshl_add_u32 v5, s10, 1, v5
    v_cmp_gt_u32 vcc, 32, v1
    s_lshr_b32 s11, s9, 1
    s_add_u32 s11, s11, 12
    v_cndmask_b32 v4, v5, v4, vcc
    v_mov_b32 v5, s9
    v_mov_b32 v11, s11
    v_cndmask_b32 v5, v5, v11, vcc
    v_cmp_gt_u32 vcc, 16, v1
    s_add_u32 s9, s9, 8
    v_mov_b32 v11, s9
    v_cndmask_b32 v5, v5, v11, vcc
    v_lshl_add_u32 v11, v4, 4, v5
    v_lshlrev_b32 v11, 7, v11
    v_add_u32 v11, 15794176, v11
    s_and_b32 s9, s2, 7
    s_lshl_b32 s12, s9, 2
    s_bfe_u32 s9, s2, 0x20003
    s_add_u32 s12, s12, s9
    s_lshr_b32 s9, s2, 5
    s_lshl_b32 s9, s9, 2
    s_add_u32 s9, s9, s8
    s_lshl_b32 s13, s9, 11
    s_lshl_b32 s10, s12, 16
    s_add_u32 s13, s13, s10
    s_lshl_b32 s15, s9, 16
    s_lshl_b32 s10, s12, 10
    s_add_u32 s15, s15, s10
    s_add_u32 s15, s15, 6291456
    s_lshl_b32 s16, s9, 5
    s_add_u32 s16, s16, s12
    s_lshl_b32 s16, s16, 7
    s_add_u32 s16, s16, 15859712
    s_lshl_b32 s12, s12, 17
    s_add_u32 s12, s12, 2097152
    s_lshl_b32 s11, s52, 2
    s_and_b32 s9, s3, 1
    s_lshl_b32 s9, s9, 1
    s_add_u32 s11, s11, s9
    s_and_b32 s9, s53, 7
    s_lshl_b32 s9, s9, 8
    s_and_b32 s10, s3, 2
    s_lshl_b32 s10, s10, 6
    s_add_u32 s9, s9, s10
    s_add_u32 s9, s9, s11
    s_lshl_b32 s42, s53, 9
    s_add_u32 s42, s42, s10
    s_add_u32 s42, s42, s11
    s_sub_u32 s42, s42, 6144
    s_lshl_b32 s42, s42, 11
    s_add_u32 s42, s42, 2097152
    s_add_u32 s43, s42, 131072
    v_and_b32 v4, 0x33, v1
    v_and_b32 v5, 4, v1
    v_lshl_or_b32 v4, v5, 1, v4
    v_and_b32 v5, 8, v1
    v_lshrrev_b32 v5, 1, v5
    v_or_b32 v4, v4, v5
    v_lshlrev_b32 v19, 4, v4
    s_cmp_ge_u32 s53, 8
    s_cselect_b64 vcc, -1, 0
    s_cselect_b32 s11, 11, 10
    s_cselect_b32 s10, 2097152, 0
    s_cselect_b32 s36, 1.0, 0x3eb8aa3b
    s_lshl_b32 s22, s9, s11
    s_add_u32 s22, s22, s10
    s_lshl_b32 s23, 64, s11
    s_add_u32 s23, s23, s22
    s_lshl_b32 s40, 1, s11
    s_mov_b32 s37, s36
    v_cndmask_b32 v19, v3, v19, vcc
    v_and_b32 v5, 15, v1
    v_lshlrev_b32 v255, 4, v5
    v_bfe_u32 v4, v1, 4, 1
    v_lshl_add_u32 v255, v4, 19, v255
    v_lshrrev_b32 v4, 5, v1
    v_lshl_add_u32 v255, v4, 8, v255
    s_mov_b32 s38, 0xbdd2d3e8
    s_mov_b32 s39, 0xbdd2d3e8
    s_add_u32 s11, s53, 16
    s_lshl_b32 s9, s52, 1
    s_and_b32 s10, s3, 1
    s_add_u32 s9, s9, s10
    s_mul_i32 s57, s9, 224
    s_lshl_b32 s9, s11, 2
    s_add_u32 s57, s57, s9
    s_and_b32 s9, s3, 2
    s_add_u32 s57, s57, s9
    s_lshl_b32 s57, s57, 10
    s_add_u32 s57, s57, 8388608
    s_add_u32 s58, s57, 114688
    s_waitcnt lgkmcnt(0)
    s_mov_b64 s[24:25], s[76:77]
    s_mov_b32 s26, 0x200000
    s_mov_b32 s27, 0x20000
    s_mov_b64 s[28:29], s[84:85]
    s_mov_b32 s30, 0x1c0000
    s_mov_b32 s31, 0x20000
    s_mov_b64 s[32:33], s[86:87]
    s_mov_b32 s34, 0x1c0000
    s_mov_b32 s35, 0x20000
    s_mov_b64 s[44:45], s[94:95]
    s_or_b32 s9, s2, s8
    s_cmp_lg_u32 s9, 0
    s_cbranch_scc1 Ap_np
    s_memrealtime s[48:49]
    s_waitcnt lgkmcnt(0)
    s_or_b32 s48, s48, 1
    v_mov_b32 v4, 0
    v_mov_b32 v6, s48
    v_mov_b32 v7, s49
    s_mov_b64 exec, 1
    buffer_store_dwordx2 v[6:7], v4, s[44:47], 0 offen sc1
    s_mov_b64 exec, -1
Ap_np:
    s_mov_b32 s50, 0
    s_barrier
    ds_read_b128 v[200:203], v12 offset:0
    ds_read_b64_tr_b16 v[216:217], v16 offset:0
    ds_read_b64_tr_b16 v[218:219], v16 offset:512
    ds_read_b128 v[204:207], v12 offset:4096
    ds_read_b64_tr_b16 v[220:221], v17 offset:0
    ds_read_b64_tr_b16 v[222:223], v17 offset:512
    ds_read_b64_tr_b16 v[224:225], v18 offset:0
    ds_read_b64_tr_b16 v[226:227], v18 offset:512
    ds_read_b128 v[24:27], v13 offset:0
    ds_read_b64_tr_b16 v[32:33], v16 offset:2048
    ds_read_b64_tr_b16 v[34:35], v16 offset:2560
    ds_read_b128 v[28:31], v13 offset:4096
    ds_read_b64_tr_b16 v[36:37], v17 offset:2048
    ds_read_b64_tr_b16 v[38:39], v17 offset:2560
    ds_read_b64_tr_b16 v[40:41], v18 offset:2048
    ds_read_b64_tr_b16 v[42:43], v18 offset:2560
    s_cmp_ge_u32 s53, 12
    s_cbranch_scc1 Ap_ls_in
    s_branch Ap_lm_in
Dp_l1:
    s_waitcnt vmcnt(10)
    s_barrier
    s_and_b32 s9, s36, 15
    s_mul_i32 s10, s9, s38
    s_mov_b32 m0, s41
    s_add_u32 s10, s10, s39
    buffer_load_dwordx4 v14, s[16:19], s10 offen lds
    s_add_u32 m0, s41, 4096
    s_mul_i32 s9, s9, 98304
    buffer_load_dwordx4 v15, s[20:23], s10 offen lds
    s_add_u32 m0, s41, 8192
    s_add_u32 s9, s9, s51
    buffer_load_dwordx4 v16, s[24:27], s9 offen lds
    s_xor_b32 s67, s67, s66
    s_add_u32 s36, s36, s67
    s_add_u32 s37, s37, 1
    s_add_u32 s41, s41, 12288
    s_cmp_ge_u32 s41, 65536
    s_cselect_b32 s41, s42, s41
    s_bfe_u32 s9, s36, 0x30001
    s_lshl_b32 s9, s9, 7
    s_and_b32 s10, s37, 1
    s_lshl_b32 s10, s10, 16
    s_add_u32 s9, s9, s10
    s_add_u32 s9, s9, s40
    s_cmp_ge_u32 s37, 12
    s_cselect_b32 s10, 12, 0
    s_sub_u32 s10, s37, s10
    s_lshl_b32 s10, s10, 13
    s_add_u32 s10, s10, s43
    s_cmp_lt_u32 s37, 16
    s_cselect_b32 m0, s10, 196608
    s_cselect_b32 s9, s9, 1073741824
    buffer_load_dwordx4 v12, s[12:15], s9 offen lds
    buffer_load_dwordx4 v13, s[12:15], s9 offen offset:1024 lds
    s_cmp_lg_u32 s37, 9
    s_cbranch_scc1 Dp_ng
    buffer_load_dwordx4 v[240:243], v3, s[28:31], 0 offen
    buffer_load_dwordx4 v[244:247], v3, s[12:15], s61 offen
    buffer_load_dwordx4 v[248:251], v3, s[12:15], s61 offen offset:1024
Dp_ng:
    s_cmp_lg_u32 s37, 6
    s_cbranch_scc1 Dp_n6
    v_and_b32 v4, 31, v1
    v_lshlrev_b32 v192, 7, v4
    v_bfe_u32 v4, v1, 1, 3
    v_lshrrev_b32 v5, 5, v1
    v_xor_b32 v4, v4, v5
    v_lshl_add_u32 v192, v4, 4, v192
    s_and_b32 s9, s3, 1
    s_lshl_b32 s9, s9, 13
    s_add_u32 s9, s9, 98304
    v_add_u32 v192, s9, v192
    v_xor_b32 v193, 32, v192
    v_xor_b32 v194, 64, v192
    v_xor_b32 v195, 96, v192
    v_lshrrev_b32 v4, 5, v1
    v_mul_u32_u24 v196, 1024, v4
    v_bfe_u32 v4, v1, 2, 2
    v_mul_u32_u24 v4, 128, v4
    v_bfe_u32 v5, v1, 4, 1
    v_mul_u32_u24 v5, 4096, v5
    v_add3_u32 v196, v196, v4, v5
    v_and_b32 v4, 1, v1
    v_and_b32 v5, 2, v1
    v_lshl_add_u32 v196, v4, 4, v196
    v_lshl_add_u32 v196, v5, 2, v196
    v_bfe_u32 v4, v1, 3, 2
    v_and_b32 v5, 2, v2
    v_xor_b32 v4, v4, v5
    v_lshl_add_u32 v196, v4, 5, v196
    v_add_u32 v196, 16384, v196
    v_xor_b32 v197, 32, v196
    s_lshl_b32 s9, s52, 1
    s_and_b32 s10, s3, 1
    s_add_u32 s9, s9, s10
    s_mul_i32 s57, s9, 224
    s_lshl_b32 s9, s53, 2
    s_add_u32 s57, s57, s9
    s_and_b32 s9, s3, 2
    s_add_u32 s57, s57, s9
    s_lshl_b32 s57, s57, 10
    s_add_u32 s57, s57, 8388608
    s_add_u32 s58, s57, 114688
Dp_n6:
    s_cmp_lg_u32 s37, 12
    s_cbranch_scc1 Dp_n12
    s_lshr_b32 s10, s3, 1
    s_mul_i32 s10, s10, 114688
    v_add_u32 v20, s10, v3
    s_sub_u32 s10, 114688, s10
    v_add_u32 v21, s10, v3
    v_lshrrev_b32 v4, 3, v1
    v_lshlrev_b32 v4, 10, v4
    v_bfe_u32 v5, v1, 4, 1
    v_lshlrev_b32 v5, 2, v5
    v_xor_b32 v5, v5, v1
    v_and_b32 v5, 7, v5
    v_lshl_add_u32 v22, v5, 4, v4
    v_add_u32 v23, 7168, v22
    v_add_u32 v24, 14336, v22
    v_add_u32 v25, 21504, v22
    v_and_b32 v4, 31, v1
    v_lshrrev_b32 v5, 1, v2
    v_lshl_add_u32 v4, v5, 5, v4
    v_lshlrev_b32 v32, 10, v4
    v_and_b32 v5, 1, v2
    v_lshl_add_u32 v32, v5, 6, v32
    v_lshrrev_b32 v5, 5, v1
    v_lshl_add_u32 v32, v5, 4, v32
    v_lshrrev_b32 v4, 5, v1
    v_mul_u32_u24 v26, 1024, v4
    v_bfe_u32 v4, v1, 2, 2
    v_mul_u32_u24 v4, 128, v4
    v_bfe_u32 v5, v1, 4, 1
    v_mul_u32_u24 v5, 32, v5
    v_add3_u32 v26, v26, v4, v5
    v_and_b32 v4, 1, v1
    v_and_b32 v5, 2, v1
    v_lshl_add_u32 v26, v4, 4, v26
    v_lshl_add_u32 v26, v5, 2, v26
    v_lshrrev_b32 v4, 3, v1
    v_xor_b32 v4, v4, v2
    v_and_b32 v4, 1, v4
    v_lshl_add_u32 v26, v4, 6, v26
    s_mul_i32 s9, s3, 6144
    s_add_u32 s9, s9, 131072
    v_add_u32 v26, s9, v26
    v_xor_b32 v27, 64, v26
    v_and_b32 v33, 15, v1
    v_lshlrev_b32 v33, 7, v33
    s_and_b32 s9, s2, 7
    s_lshr_b32 s10, s2, 5
    v_and_b32 v4, 15, v1
    v_and_b32 v5, 1, v1
    v_lshl_add_u32 v5, s10, 1, v5
    v_cmp_gt_u32 vcc, 32, v1
    s_lshr_b32 s11, s9, 1
    s_add_u32 s11, s11, 12
    v_cndmask_b32 v4, v5, v4, vcc
    v_mov_b32 v5, s9
    v_mov_b32 v11, s11
    v_cndmask_b32 v5, v5, v11, vcc
    v_cmp_gt_u32 vcc, 16, v1
    s_add_u32 s9, s9, 8
    v_mov_b32 v11, s9
    v_cndmask_b32 v5, v5, v11, vcc
    v_lshl_add_u32 v11, v4, 4, v5
    v_lshlrev_b32 v11, 7, v11
    v_add_u32 v11, 15794176, v11
Dp_n12:
    s_cmp_lt_u32 s37, 16
    s_cbranch_scc1 Dp_l1
    s_lshl_b32 s9, s64, 2
    s_add_u32 s36, s36, s9
    s_mov_b64 s[28:29], s[84:85]
    s_mov_b32 s30, 1835008
    v_dot2_f32_bf16 v4, v244, v240, 0
    v_dot2_f32_bf16 v5, v248, v240, 0
    v_dot2_f32_bf16 v4, v245, v241, v4
    v_dot2_f32_bf16 v5, v249, v241, v5
    v_dot2_f32_bf16 v4, v246, v242, v4
    v_dot2_f32_bf16 v5, v250, v242, v5
    v_dot2_f32_bf16 v4, v247, v243, v4
    v_dot2_f32_bf16 v5, v251, v243, v5
    s_nop 3
    v_permlane32_swap_b32 v4, v5
    s_nop 1
    v_add_f32 v4, v4, v5
    s_nop 1
    v_add_f32_dpp v4, v4, v4 row_ror:8 row_mask:0xf bank_mask:0xf
    s_nop 1
    v_add_f32_dpp v4, v4, v4 row_ror:4 row_mask:0xf bank_mask:0xf
    s_nop 1
    v_add_f32_dpp v4, v4, v4 row_ror:2 row_mask:0xf bank_mask:0xf
    s_nop 1
    v_add_f32_dpp v4, v4, v4 row_ror:1 row_mask:0xf bank_mask:0xf
    v_mov_b32 v5, v4
    s_nop 1
    v_permlane16_swap_b32 v4, v5
    s_nop 1
    v_add_f32 v4, v4, v5
    v_cvt_pk_bf16_f32 v4, v4, v4
    v_lshlrev_b32 v4, 16, v4
    v_mul_f32 v4, 0xbfb8aa3b, v4
    v_exp_f32 v4, v4
    s_nop 0
    v_add_f32 v4, 1.0, v4
    v_rcp_f32 v4, v4
    s_nop 0
    v_cvt_pk_bf16_f32 v4, v4, v4
    v_lshlrev_b32 v19, 16, v4
    s_waitcnt lgkmcnt(0)
Dp_l2:
    s_waitcnt vmcnt(8)
    s_barrier
    s_and_b32 s9, s36, 15
    s_mul_i32 s10, s9, 114688
    s_add_u32 s10, s10, s51
    s_cmp_lt_u32 s37, 32
    s_mov_b32 m0, s41
    s_cselect_b32 s10, s10, 1073741824
    buffer_load_dwordx4 v17, s[28:31], s10 offen lds
    s_add_u32 m0, s41, 4096
    s_nop 0
    buffer_load_dwordx4 v18, s[32:35], s10 offen lds
    s_xor_b32 s67, s67, s66
    s_add_u32 s36, s36, s67
    s_add_u32 s37, s37, 1
    s_add_u32 s41, s41, 12288
    s_cmp_ge_u32 s41, 65536
    s_cselect_b32 s41, s42, s41
    s_bfe_u32 s9, s36, 0x30001
    s_lshl_b32 s9, s9, 7
    s_and_b32 s10, s37, 1
    s_lshl_b32 s10, s10, 16
    s_add_u32 s9, s9, s10
    s_add_u32 s9, s9, s40
    s_cmp_ge_u32 s37, 12
    s_cselect_b32 s10, 12, 0
    s_sub_u32 s10, s37, s10
    s_lshl_b32 s10, s10, 13
    s_add_u32 s10, s10, s43
    s_cmp_lt_u32 s37, 16
    s_cselect_b32 m0, s10, 196608
    s_cselect_b32 s9, s9, 1073741824
    buffer_load_dwordx4 v12, s[12:15], s9 offen lds
    buffer_load_dwordx4 v13, s[12:15], s9 offen offset:1024 lds
    s_cmp_lt_u32 s37, 19
    s_cbranch_scc1 Dp_l2
    s_setprio 1
    v_mov_b32 v6, 0
    buffer_load_dwordx2 v[6:7], v6, s[44:47], 0 offen sc1
    s_and_b32 s9, s36, 15
    s_mul_i32 s36, s9, 114688
    s_add_u32 s36, s36, s51
    s_add_u32 s38, s51, 1835008
    s_mov_b32 s62, 0
    s_mul_i32 s65, s65, 114688
    s_waitcnt vmcnt(8) lgkmcnt(0)
    s_barrier
    ds_read_b128 v[200:203], v192 offset:0
    ds_read_b64_tr_b16 v[208:209], v196 offset:0
    ds_read_b64_tr_b16 v[210:211], v196 offset:512
    ds_read_b128 v[204:207], v192 offset:4096
    ds_read_b64_tr_b16 v[212:213], v197 offset:0
    ds_read_b64_tr_b16 v[214:215], v197 offset:512
    ds_read_b128 v[216:219], v193 offset:0
    ds_read_b64_tr_b16 v[224:225], v196 offset:2048
    ds_read_b64_tr_b16 v[226:227], v196 offset:2560
    ds_read_b128 v[220:223], v193 offset:4096
    ds_read_b64_tr_b16 v[228:229], v197 offset:2048
    ds_read_b64_tr_b16 v[230:231], v197 offset:2560
    s_add_u32 m0, s42, 36864
    s_nop 0
    buffer_load_dwordx4 v17, s[28:31], s36 offen lds
    s_add_u32 m0, s42, 40960
    s_nop 0
    buffer_load_dwordx4 v18, s[32:35], s36 offen lds
    s_add_u32 s36, s36, s65
    s_sub_u32 s66, s36, 1835008
    s_cmp_ge_u32 s36, s38
    s_cselect_b32 s36, s66, s36
    s_waitcnt vmcnt(6) lgkmcnt(0)
    s_barrier
    v_mfma_f32_32x32x16_bf16 v[104:119], v[208:211], v[200:203], v[104:119]
    ds_read_b128 v[232:235], v194 offset:0
    ds_read_b64_tr_b16 v[240:241], v196 offset:12288
    ds_read_b64_tr_b16 v[242:243], v196 offset:12800
    v_mfma_f32_32x32x16_bf16 v[136:151], v[208:211], v[204:207], v[136:151]
    ds_read_b128 v[236:239], v194 offset:4096
    ds_read_b64_tr_b16 v[244:245], v197 offset:12288
    v_mfma_f32_32x32x16_bf16 v[120:135], v[212:215], v[200:203], v[120:135]
    ds_read_b64_tr_b16 v[246:247], v197 offset:12800
    ds_read_b128 v[168:171], v195 offset:0
    ds_read_b64_tr_b16 v[176:177], v196 offset:14336
    v_mfma_f32_32x32x16_bf16 v[152:167], v[212:215], v[204:207], v[152:167]
    ds_read_b64_tr_b16 v[178:179], v196 offset:14848
    ds_read_b128 v[172:175], v195 offset:4096
    s_add_u32 m0, s42, 0
    s_nop 0
    buffer_load_dwordx4 v17, s[28:31], s36 offen lds
    v_mfma_f32_32x32x16_bf16 v[104:119], v[224:227], v[216:219], v[104:119]
    ds_read_b64_tr_b16 v[180:181], v197 offset:14336
    ds_read_b64_tr_b16 v[182:183], v197 offset:14848
    v_mfma_f32_32x32x16_bf16 v[136:151], v[224:227], v[220:223], v[136:151]
    s_add_u32 m0, s42, 4096
    s_nop 0
    buffer_load_dwordx4 v18, s[32:35], s36 offen lds
    s_add_u32 s36, s36, 114688
    v_mfma_f32_32x32x16_bf16 v[120:135], v[228:231], v[216:219], v[120:135]
    v_mfma_f32_32x32x16_bf16 v[152:167], v[228:231], v[220:223], v[152:167]
    s_waitcnt vmcnt(4) lgkmcnt(0)
    s_barrier
    v_mfma_f32_32x32x16_bf16 v[104:119], v[240:243], v[232:235], v[104:119]
    ds_read_b128 v[200:203], v192 offset:16384
    ds_read_b64_tr_b16 v[208:209], v196 offset:24576
    ds_read_b64_tr_b16 v[210:211], v196 offset:25088
    v_mfma_f32_32x32x16_bf16 v[136:151], v[240:243], v[236:239], v[136:151]
    ds_read_b128 v[204:207], v192 offset:20480
    ds_read_b64_tr_b16 v[212:213], v197 offset:24576
    v_mfma_f32_32x32x16_bf16 v[120:135], v[244:247], v[232:235], v[120:135]
    ds_read_b64_tr_b16 v[214:215], v197 offset:25088
    ds_read_b128 v[216:219], v193 offset:16384
    ds_read_b64_tr_b16 v[224:225], v196 offset:26624
    v_mfma_f32_32x32x16_bf16 v[152:167], v[244:247], v[236:239], v[152:167]
    ds_read_b64_tr_b16 v[226:227], v196 offset:27136
    ds_read_b128 v[220:223], v193 offset:20480
    s_add_u32 m0, s42, 12288
    s_nop 0
    buffer_load_dwordx4 v17, s[28:31], s36 offen lds
    v_mfma_f32_32x32x16_bf16 v[104:119], v[176:179], v[168:171], v[104:119]
    ds_read_b64_tr_b16 v[228:229], v197 offset:26624
    ds_read_b64_tr_b16 v[230:231], v197 offset:27136
    v_mfma_f32_32x32x16_bf16 v[136:151], v[176:179], v[172:175], v[136:151]
    s_add_u32 m0, s42, 16384
    s_nop 0
    buffer_load_dwordx4 v18, s[32:35], s36 offen lds
    s_add_u32 s36, s36, s65
    s_sub_u32 s66, s36, 1835008
    s_cmp_ge_u32 s36, s38
    s_cselect_b32 s36, s66, s36
    v_mfma_f32_32x32x16_bf16 v[120:135], v[180:183], v[168:171], v[120:135]
    v_mfma_f32_32x32x16_bf16 v[152:167], v[180:183], v[172:175], v[152:167]
    s_waitcnt vmcnt(4) lgkmcnt(0)
    s_barrier
    v_mfma_f32_32x32x16_bf16 v[104:119], v[208:211], v[200:203], v[104:119]
    ds_read_b128 v[232:235], v194 offset:16384
    ds_read_b64_tr_b16 v[240:241], v196 offset:36864
    ds_read_b64_tr_b16 v[242:243], v196 offset:37376
    v_mfma_f32_32x32x16_bf16 v[136:151], v[208:211], v[204:207], v[136:151]
    ds_read_b128 v[236:239], v194 offset:20480
    ds_read_b64_tr_b16 v[244:245], v197 offset:36864
    v_mfma_f32_32x32x16_bf16 v[120:135], v[212:215], v[200:203], v[120:135]
    ds_read_b64_tr_b16 v[246:247], v197 offset:37376
    ds_read_b128 v[168:171], v195 offset:16384
    ds_read_b64_tr_b16 v[176:177], v196 offset:38912
    v_mfma_f32_32x32x16_bf16 v[152:167], v[212:215], v[204:207], v[152:167]
    ds_read_b64_tr_b16 v[178:179], v196 offset:39424
    ds_read_b128 v[172:175], v195 offset:20480
    s_add_u32 m0, s42, 24576
    s_nop 0
    buffer_load_dwordx4 v17, s[28:31], s36 offen lds
    v_mfma_f32_32x32x16_bf16 v[104:119], v[224:227], v[216:219], v[104:119]
    ds_read_b64_tr_b16 v[180:181], v197 offset:38912
    ds_read_b64_tr_b16 v[182:183], v197 offset:39424
    v_mfma_f32_32x32x16_bf16 v[136:151], v[224:227], v[220:223], v[136:151]
    s_add_u32 m0, s42, 28672
    s_nop 0
    buffer_load_dwordx4 v18, s[32:35], s36 offen lds
    s_add_u32 s36, s36, 114688
    v_mfma_f32_32x32x16_bf16 v[120:135], v[228:231], v[216:219], v[120:135]
    v_add_u32 v192, 32768, v192
    v_add_u32 v193, 32768, v193
    v_add_u32 v194, 32768, v194
    v_add_u32 v195, 32768, v195
    v_mfma_f32_32x32x16_bf16 v[152:167], v[228:231], v[220:223], v[152:167]
Dp_l3:
    s_waitcnt vmcnt(4) lgkmcnt(0)
    s_barrier
    v_mfma_f32_32x32x16_bf16 v[104:119], v[240:243], v[232:235], v[104:119]
    ds_read_b128 v[200:203], v192 offset:0
    ds_read_b64_tr_b16 v[208:209], v196 offset:0
    ds_read_b64_tr_b16 v[210:211], v196 offset:512
    v_mfma_f32_32x32x16_bf16 v[136:151], v[240:243], v[236:239], v[136:151]
    ds_read_b128 v[204:207], v192 offset:4096
    ds_read_b64_tr_b16 v[212:213], v197 offset:0
    v_mfma_f32_32x32x16_bf16 v[120:135], v[244:247], v[232:235], v[120:135]
    ds_read_b64_tr_b16 v[214:215], v197 offset:512
    ds_read_b128 v[216:219], v193 offset:0
    ds_read_b64_tr_b16 v[224:225], v196 offset:2048
    v_mfma_f32_32x32x16_bf16 v[152:167], v[244:247], v[236:239], v[152:167]
    ds_read_b64_tr_b16 v[226:227], v196 offset:2560
    ds_read_b128 v[220:223], v193 offset:4096
    v_mfma_f32_32x32x16_bf16 v[104:119], v[176:179], v[168:171], v[104:119]
    ds_read_b64_tr_b16 v[228:229], v197 offset:2048
    ds_read_b64_tr_b16 v[230:231], v197 offset:2560
    v_mfma_f32_32x32x16_bf16 v[136:151], v[176:179], v[172:175], v[136:151]
    v_mfma_f32_32x32x16_bf16 v[120:135], v[180:183], v[168:171], v[120:135]
    v_mfma_f32_32x32x16_bf16 v[152:167], v[180:183], v[172:175], v[152:167]
    s_waitcnt vmcnt(2) lgkmcnt(0)
    s_barrier
    v_mfma_f32_32x32x16_bf16 v[104:119], v[208:211], v[200:203], v[104:119]
    ds_read_b128 v[232:235], v194 offset:0
    ds_read_b64_tr_b16 v[240:241], v196 offset:12288
    ds_read_b64_tr_b16 v[242:243], v196 offset:12800
    v_mfma_f32_32x32x16_bf16 v[136:151], v[208:211], v[204:207], v[136:151]
    ds_read_b128 v[236:239], v194 offset:4096
    ds_read_b64_tr_b16 v[244:245], v197 offset:12288
    v_mfma_f32_32x32x16_bf16 v[120:135], v[212:215], v[200:203], v[120:135]
    ds_read_b64_tr_b16 v[246:247], v197 offset:12800
    ds_read_b128 v[168:171], v195 offset:0
    ds_read_b64_tr_b16 v[176:177], v196 offset:14336
    v_mfma_f32_32x32x16_bf16 v[152:167], v[212:215], v[204:207], v[152:167]
    ds_read_b64_tr_b16 v[178:179], v196 offset:14848
    ds_read_b128 v[172:175], v195 offset:4096
    v_mfma_f32_32x32x16_bf16 v[104:119], v[224:227], v[216:219], v[104:119]
    ds_read_b64_tr_b16 v[180:181], v197 offset:14336
    ds_read_b64_tr_b16 v[182:183], v197 offset:14848
    v_mfma_f32_32x32x16_bf16 v[136:151], v[224:227], v[220:223], v[136:151]
    v_mfma_f32_32x32x16_bf16 v[120:135], v[228:231], v[216:219], v[120:135]
    v_mfma_f32_32x32x16_bf16 v[152:167], v[228:231], v[220:223], v[152:167]
    s_waitcnt vmcnt(0) lgkmcnt(0)
    s_barrier
    v_mfma_f32_32x32x16_bf16 v[104:119], v[240:243], v[232:235], v[104:119]
    ds_read_b128 v[200:203], v192 offset:16384
    ds_read_b64_tr_b16 v[208:209], v196 offset:24576
    ds_read_b64_tr_b16 v[210:211], v196 offset:25088
    v_mfma_f32_32x32x16_bf16 v[136:151], v[240:243], v[236:239], v[136:151]
    ds_read_b128 v[204:207], v192 offset:20480
    ds_read_b64_tr_b16 v[212:213], v197 offset:24576
    v_mfma_f32_32x32x16_bf16 v[120:135], v[244:247], v[232:235], v[120:135]
    ds_read_b64_tr_b16 v[214:215], v197 offset:25088
    ds_read_b128 v[216:219], v193 offset:16384
    ds_read_b64_tr_b16 v[224:225], v196 offset:26624
    v_mfma_f32_32x32x16_bf16 v[152:167], v[244:247], v[236:239], v[152:167]
    ds_read_b64_tr_b16 v[226:227], v196 offset:27136
    ds_read_b128 v[220:223], v193 offset:20480
    v_mfma_f32_32x32x16_bf16 v[104:119], v[176:179], v[168:171], v[104:119]
    ds_read_b64_tr_b16 v[228:229], v197 offset:26624
    ds_read_b64_tr_b16 v[230:231], v197 offset:27136
    v_mfma_f32_32x32x16_bf16 v[136:151], v[176:179], v[172:175], v[136:151]
    v_mfma_f32_32x32x16_bf16 v[120:135], v[180:183], v[168:171], v[120:135]
    v_mfma_f32_32x32x16_bf16 v[152:167], v[180:183], v[172:175], v[152:167]
    s_waitcnt vmcnt(0) lgkmcnt(0)
    s_barrier
    v_mfma_f32_32x32x16_bf16 v[104:119], v[208:211], v[200:203], v[104:119]
    ds_read_b128 v[232:235], v194 offset:16384
    ds_read_b64_tr_b16 v[240:241], v196 offset:36864
    ds_read_b64_tr_b16 v[242:243], v196 offset:37376
    v_mfma_f32_32x32x16_bf16 v[136:151], v[208:211], v[204:207], v[136:151]
    ds_read_b128 v[236:239], v194 offset:20480
    ds_read_b64_tr_b16 v[244:245], v197 offset:36864
    v_mfma_f32_32x32x16_bf16 v[120:135], v[212:215], v[200:203], v[120:135]
    ds_read_b64_tr_b16 v[246:247], v197 offset:37376
    ds_read_b128 v[168:171], v195 offset:16384
    ds_read_b64_tr_b16 v[176:177], v196 offset:38912
    v_mfma_f32_32x32x16_bf16 v[152:167], v[212:215], v[204:207], v[152:167]
    ds_read_b64_tr_b16 v[178:179], v196 offset:39424
    ds_read_b128 v[172:175], v195 offset:20480
    v_mfma_f32_32x32x16_bf16 v[104:119], v[224:227], v[216:219], v[104:119]
    ds_read_b64_tr_b16 v[180:181], v197 offset:38912
    ds_read_b64_tr_b16 v[182:183], v197 offset:39424
    v_mfma_f32_32x32x16_bf16 v[136:151], v[224:227], v[220:223], v[136:151]
    v_mfma_f32_32x32x16_bf16 v[120:135], v[228:231], v[216:219], v[120:135]
    s_cmp_eq_u32 s62, 0
    s_cselect_b32 s9, -2, 1
    s_lshl_b32 s9, s9, 15
    v_add_u32 v192, s9, v192
    v_add_u32 v193, s9, v193
    v_add_u32 v194, s9, v194
    v_add_u32 v195, s9, v195
    s_add_u32 s62, s62, 1
    s_cmp_lt_u32 s62, 3
    v_mfma_f32_32x32x16_bf16 v[152:167], v[228:231], v[220:223], v[152:167]
    s_cbranch_scc1 Dp_l3
    s_waitcnt vmcnt(0) lgkmcnt(0)
    v_mfma_f32_32x32x16_bf16 v[104:119], v[240:243], v[232:235], v[104:119]
    v_mfma_f32_32x32x16_bf16 v[136:151], v[240:243], v[236:239], v[136:151]
    v_mfma_f32_32x32x16_bf16 v[120:135], v[244:247], v[232:235], v[120:135]
    v_mfma_f32_32x32x16_bf16 v[152:167], v[244:247], v[236:239], v[152:167]
    v_mfma_f32_32x32x16_bf16 v[104:119], v[176:179], v[168:171], v[104:119]
    v_mfma_f32_32x32x16_bf16 v[136:151], v[176:179], v[172:175], v[136:151]
    v_mfma_f32_32x32x16_bf16 v[120:135], v[180:183], v[168:171], v[120:135]
    v_mfma_f32_32x32x16_bf16 v[152:167], v[180:183], v[172:175], v[152:167]
    s_mov_b32 s50, 0
Dp_tg:
    v_readfirstlane_b32 s48, v6
    v_readfirstlane_b32 s49, v7
    s_add_u32 s50, s50, 1
    s_cmp_lg_u64 s[48:49], 0
    s_cbranch_scc1 Dp_tgd
    s_cmp_gt_u32 s50, 131072
    s_cbranch_scc1 Dp_tgd
    s_sleep 4
    v_mov_b32 v6, 0
    buffer_load_dwordx2 v[6:7], v6, s[44:47], 0 offen sc1
    s_waitcnt vmcnt(0)
    s_branch Dp_tg
Dp_tgd:
    v_mov_b32 v168, 0xc0135761
    v_mov_b32 v169, 0xc0135761
    s_mov_b32 s38, 0xbdd2d3e8
    s_mov_b32 s39, 0xbdd2d3e8
    s_setprio 0
    s_nop 3
    buffer_load_dwordx2 v[8:9], v11, s[4:7], 0 offen sc1
    v_pk_mul_f32 v[176:177], v[104:105], v[104:105]
    v_pk_mul_f32 v[178:179], v[106:107], v[106:107]
    v_pk_mul_f32 v[180:181], v[108:109], v[108:109]
    v_pk_mul_f32 v[182:183], v[110:111], v[110:111]
    v_pk_fma_f32 v[176:177], v[176:177], s[38:39], v[168:169]
    v_pk_fma_f32 v[178:179], v[178:179], s[38:39], v[168:169]
    v_pk_fma_f32 v[180:181], v[180:181], s[38:39], v[168:169]
    v_pk_fma_f32 v[182:183], v[182:183], s[38:39], v[168:169]
    v_pk_mul_f32 v[176:177], v[176:177], v[104:105]
    v_pk_mul_f32 v[178:179], v[178:179], v[106:107]
    v_pk_mul_f32 v[180:181], v[180:181], v[108:109]
    v_pk_mul_f32 v[182:183], v[182:183], v[110:111]
    v_exp_f32 v176, v176
    v_exp_f32 v177, v177
    v_exp_f32 v178, v178
    v_exp_f32 v179, v179
    v_exp_f32 v180, v180
    v_exp_f32 v181, v181
    v_exp_f32 v182, v182
    v_exp_f32 v183, v183
    v_pk_mul_f32 v[104:105], v[104:105], v[112:113]
    v_pk_mul_f32 v[106:107], v[106:107], v[114:115]
    v_pk_mul_f32 v[108:109], v[108:109], v[116:117]
    v_pk_mul_f32 v[110:111], v[110:111], v[118:119]
    v_pk_add_f32 v[176:177], v[176:177], 1.0 op_sel_hi:[1,0]
    v_pk_add_f32 v[178:179], v[178:179], 1.0 op_sel_hi:[1,0]
    v_pk_add_f32 v[180:181], v[180:181], 1.0 op_sel_hi:[1,0]
    v_pk_add_f32 v[182:183], v[182:183], 1.0 op_sel_hi:[1,0]
    v_rcp_f32 v176, v176
    v_rcp_f32 v177, v177
    v_rcp_f32 v178, v178
    v_rcp_f32 v179, v179
    v_rcp_f32 v180, v180
    v_rcp_f32 v181, v181
    v_rcp_f32 v182, v182
    v_rcp_f32 v183, v183
    s_nop 0
    v_pk_mul_f32 v[104:105], v[104:105], v[176:177]
    v_pk_mul_f32 v[106:107], v[106:107], v[178:179]
    v_pk_mul_f32 v[108:109], v[108:109], v[180:181]
    v_pk_mul_f32 v[110:111], v[110:111], v[182:183]
    v_cvt_pk_bf16_f32 v240, v104, v105
    v_cvt_pk_bf16_f32 v241, v106, v107
    v_cvt_pk_bf16_f32 v242, v108, v109
    v_cvt_pk_bf16_f32 v243, v110, v111
    v_pk_mul_f32 v[176:177], v[136:137], v[136:137]
    v_pk_mul_f32 v[178:179], v[138:139], v[138:139]
    v_pk_mul_f32 v[180:181], v[140:141], v[140:141]
    v_pk_mul_f32 v[182:183], v[142:143], v[142:143]
    v_pk_fma_f32 v[176:177], v[176:177], s[38:39], v[168:169]
    v_pk_fma_f32 v[178:179], v[178:179], s[38:39], v[168:169]
    v_pk_fma_f32 v[180:181], v[180:181], s[38:39], v[168:169]
    v_pk_fma_f32 v[182:183], v[182:183], s[38:39], v[168:169]
    v_pk_mul_f32 v[176:177], v[176:177], v[136:137]
    v_pk_mul_f32 v[178:179], v[178:179], v[138:139]
    v_pk_mul_f32 v[180:181], v[180:181], v[140:141]
    v_pk_mul_f32 v[182:183], v[182:183], v[142:143]
    v_exp_f32 v176, v176
    v_exp_f32 v177, v177
    v_exp_f32 v178, v178
    v_exp_f32 v179, v179
    v_exp_f32 v180, v180
    v_exp_f32 v181, v181
    v_exp_f32 v182, v182
    v_exp_f32 v183, v183
    v_pk_mul_f32 v[136:137], v[136:137], v[144:145]
    v_pk_mul_f32 v[138:139], v[138:139], v[146:147]
    v_pk_mul_f32 v[140:141], v[140:141], v[148:149]
    v_pk_mul_f32 v[142:143], v[142:143], v[150:151]
    v_pk_add_f32 v[176:177], v[176:177], 1.0 op_sel_hi:[1,0]
    v_pk_add_f32 v[178:179], v[178:179], 1.0 op_sel_hi:[1,0]
    v_pk_add_f32 v[180:181], v[180:181], 1.0 op_sel_hi:[1,0]
    v_pk_add_f32 v[182:183], v[182:183], 1.0 op_sel_hi:[1,0]
    v_rcp_f32 v176, v176
    v_rcp_f32 v177, v177
    v_rcp_f32 v178, v178
    v_rcp_f32 v179, v179
    v_rcp_f32 v180, v180
    v_rcp_f32 v181, v181
    v_rcp_f32 v182, v182
    v_rcp_f32 v183, v183
    s_nop 0
    v_pk_mul_f32 v[136:137], v[136:137], v[176:177]
    v_pk_mul_f32 v[138:139], v[138:139], v[178:179]
    v_pk_mul_f32 v[140:141], v[140:141], v[180:181]
    v_pk_mul_f32 v[142:143], v[142:143], v[182:183]
    v_cvt_pk_bf16_f32 v248, v136, v137
    v_cvt_pk_bf16_f32 v249, v138, v139
    v_cvt_pk_bf16_f32 v250, v140, v141
    v_cvt_pk_bf16_f32 v251, v142, v143
    s_setprio 1
    s_barrier
    s_mov_b32 s50, 0
    s_waitcnt vmcnt(0)
    s_branch D_f1_pc
D_f1_pl:
    buffer_load_dwordx2 v[8:9], v11, s[4:7], 0 offen sc1
    s_waitcnt vmcnt(0)
D_f1_pc:
    v_cmp_ne_u64 vcc, s[48:49], v[8:9]
    s_add_u32 s50, s50, 1
    s_cmp_gt_u32 s50, 131072
    s_cbranch_scc1 D_f1_pd
    s_cbranch_vccz D_f1_pd
    s_sleep 1
    s_branch D_f1_pl
D_f1_pd:
    s_add_u32 s56, s56, 16384
    s_mov_b32 m0, s56
    s_add_u32 s55, s55, 16384
    buffer_load_dwordx4 v10, s[4:7], s55 offen sc1 lds
    buffer_load_dwordx4 v10, s[4:7], s55 offen offset:1024 sc1 lds
    buffer_load_dwordx4 v10, s[4:7], s55 offen offset:2048 sc1 lds
    buffer_load_dwordx4 v10, s[4:7], s55 offen offset:3072 sc1 lds
    v_pk_mul_f32 v[176:177], v[120:121], v[120:121]
    v_pk_mul_f32 v[178:179], v[122:123], v[122:123]
    v_pk_mul_f32 v[180:181], v[124:125], v[124:125]
    v_pk_mul_f32 v[182:183], v[126:127], v[126:127]
    v_pk_fma_f32 v[176:177], v[176:177], s[38:39], v[168:169]
    v_pk_fma_f32 v[178:179], v[178:179], s[38:39], v[168:169]
    v_pk_fma_f32 v[180:181], v[180:181], s[38:39], v[168:169]
    v_pk_fma_f32 v[182:183], v[182:183], s[38:39], v[168:169]
    v_pk_mul_f32 v[176:177], v[176:177], v[120:121]
    v_pk_mul_f32 v[178:179], v[178:179], v[122:123]
    v_pk_mul_f32 v[180:181], v[180:181], v[124:125]
    v_pk_mul_f32 v[182:183], v[182:183], v[126:127]
    v_exp_f32 v176, v176
    v_exp_f32 v177, v177
    v_exp_f32 v178, v178
    v_exp_f32 v179, v179
    v_exp_f32 v180, v180
    v_exp_f32 v181, v181
    v_exp_f32 v182, v182
    v_exp_f32 v183, v183
    v_pk_mul_f32 v[120:121], v[120:121], v[128:129]
    v_pk_mul_f32 v[122:123], v[122:123], v[130:131]
    v_pk_mul_f32 v[124:125], v[124:125], v[132:133]
    v_pk_mul_f32 v[126:127], v[126:127], v[134:135]
    v_pk_add_f32 v[176:177], v[176:177], 1.0 op_sel_hi:[1,0]
    v_pk_add_f32 v[178:179], v[178:179], 1.0 op_sel_hi:[1,0]
    v_pk_add_f32 v[180:181], v[180:181], 1.0 op_sel_hi:[1,0]
    v_pk_add_f32 v[182:183], v[182:183], 1.0 op_sel_hi:[1,0]
    v_rcp_f32 v176, v176
    v_rcp_f32 v177, v177
    v_rcp_f32 v178, v178
    v_rcp_f32 v179, v179
    v_rcp_f32 v180, v180
    v_rcp_f32 v181, v181
    v_rcp_f32 v182, v182
    v_rcp_f32 v183, v183
    s_nop 0
    v_pk_mul_f32 v[120:121], v[120:121], v[176:177]
    v_pk_mul_f32 v[122:123], v[122:123], v[178:179]
    v_pk_mul_f32 v[124:125], v[124:125], v[180:181]
    v_pk_mul_f32 v[126:127], v[126:127], v[182:183]
    v_cvt_pk_bf16_f32 v244, v120, v121
    v_cvt_pk_bf16_f32 v245, v122, v123
    v_cvt_pk_bf16_f32 v246, v124, v125
    v_cvt_pk_bf16_f32 v247, v126, v127
    v_pk_mul_f32 v[176:177], v[152:153], v[152:153]
    v_pk_mul_f32 v[178:179], v[154:155], v[154:155]
    v_pk_mul_f32 v[180:181], v[156:157], v[156:157]
    v_pk_mul_f32 v[182:183], v[158:159], v[158:159]
    v_pk_fma_f32 v[176:177], v[176:177], s[38:39], v[168:169]
    v_pk_fma_f32 v[178:179], v[178:179], s[38:39], v[168:169]
    v_pk_fma_f32 v[180:181], v[180:181], s[38:39], v[168:169]
    v_pk_fma_f32 v[182:183], v[182:183], s[38:39], v[168:169]
    v_pk_mul_f32 v[176:177], v[176:177], v[152:153]
    v_pk_mul_f32 v[178:179], v[178:179], v[154:155]
    v_pk_mul_f32 v[180:181], v[180:181], v[156:157]
    v_pk_mul_f32 v[182:183], v[182:183], v[158:159]
    v_exp_f32 v176, v176
    v_exp_f32 v177, v177
    v_exp_f32 v178, v178
    v_exp_f32 v179, v179
    v_exp_f32 v180, v180
    v_exp_f32 v181, v181
    v_exp_f32 v182, v182
    v_exp_f32 v183, v183
    v_pk_mul_f32 v[152:153], v[152:153], v[160:161]
    v_pk_mul_f32 v[154:155], v[154:155], v[162:163]
    v_pk_mul_f32 v[156:157], v[156:157], v[164:165]
    v_pk_mul_f32 v[158:159], v[158:159], v[166:167]
    v_pk_add_f32 v[176:177], v[176:177], 1.0 op_sel_hi:[1,0]
    v_pk_add_f32 v[178:179], v[178:179], 1.0 op_sel_hi:[1,0]
    v_pk_add_f32 v[180:181], v[180:181], 1.0 op_sel_hi:[1,0]
    v_pk_add_f32 v[182:183], v[182:183], 1.0 op_sel_hi:[1,0]
    v_rcp_f32 v176, v176
    v_rcp_f32 v177, v177
    v_rcp_f32 v178, v178
    v_rcp_f32 v179, v179
    v_rcp_f32 v180, v180
    v_rcp_f32 v181, v181
    v_rcp_f32 v182, v182
    v_rcp_f32 v183, v183
    s_nop 0
    v_pk_mul_f32 v[152:153], v[152:153], v[176:177]
    v_pk_mul_f32 v[154:155], v[154:155], v[178:179]
    v_pk_mul_f32 v[156:157], v[156:157], v[180:181]
    v_pk_mul_f32 v[158:159], v[158:159], v[182:183]
    v_cvt_pk_bf16_f32 v252, v152, v153
    v_cvt_pk_bf16_f32 v253, v154, v155
    v_cvt_pk_bf16_f32 v254, v156, v157
    v_cvt_pk_bf16_f32 v255, v158, v159
    buffer_store_dwordx4 v[240:243], v3, s[4:7], s57 offen offset:0 sc1
    buffer_store_dwordx4 v[244:247], v3, s[4:7], s57 offen offset:1024 sc1
    buffer_store_dwordx4 v[248:251], v3, s[4:7], s58 offen offset:0 sc1
    buffer_store_dwordx4 v[252:255], v3, s[4:7], s58 offen offset:1024 sc1
    v_lshrrev_b32 v4, 5, v1
    v_lshlrev_b32 v4, 2, v4
    buffer_store_dword v19, v4, s[4:7], s59 offen sc1
    v_mov_b64 v[120:121], 0
    v_mov_b64 v[122:123], 0
    v_mov_b64 v[124:125], 0
    v_mov_b64 v[126:127], 0
    s_mov_b64 s[12:13], s[88:89]
    s_mov_b32 s14, 0x1c0000
    s_mov_b32 s15, 0x20000
    s_mov_b64 s[16:17], s[92:93]
    s_mov_b32 s18, 0x200000
    s_mov_b32 s19, 0x20000
    s_mov_b64 s[20:21], s[80:81]
    s_mov_b32 s22, 0x80000
    s_mov_b32 s23, 0x20000
    v_mov_b32 v4, 155648
    v_mov_b32 v5, 0
    ds_write_b32 v4, v5
    s_and_b32 s9, s2, 7
    s_lshl_b32 s24, s9, 2
    s_bfe_u32 s9, s2, 0x20003
    s_add_u32 s24, s24, s9
    s_lshr_b32 s25, s2, 5
    s_mul_i32 s30, s25, 7
    s_lshr_b32 s30, s30, 1
    s_mul_i32 s9, s9, 7
    s_add_u32 s30, s30, s9
    s_sub_u32 s9, s30, 28
    s_cmp_ge_u32 s30, 28
    s_cselect_b32 s30, s9, s30
    s_mul_i32 s9, s3, 28
    s_add_u32 s9, s9, s30
    s_lshl_b32 s26, s9, 14
    s_lshl_b32 s10, s25, 7
    s_add_u32 s26, s26, s10
    s_mul_i32 s27, s3, 6144
    s_add_u32 s27, s27, 131072
    s_mul_i32 s28, s24, 229376
    s_lshl_b32 s9, s9, 10
    s_add_u32 s28, s28, s9
    s_add_u32 s28, s28, 8388608
    s_lshr_b32 s11, s24, 1
    s_lshl_b32 s11, s11, 11
    s_add_u32 s11, s11, 15826944
    s_setprio 0
    s_waitcnt vmcnt(5) lgkmcnt(0)
    s_barrier
D_kv2:
    s_add_u32 s56, s56, 16384
    s_mov_b32 m0, s56
    s_add_u32 s55, s55, 16384
    buffer_load_dwordx4 v10, s[4:7], s55 offen sc1 lds
    buffer_load_dwordx4 v10, s[4:7], s55 offen offset:1024 sc1 lds
    buffer_load_dwordx4 v10, s[4:7], s55 offen offset:2048 sc1 lds
    buffer_load_dwordx4 v10, s[4:7], s55 offen offset:3072 sc1 lds
    s_cmp_lt_u32 s56, 114688
    s_cbranch_scc1 D_kv2
    s_waitcnt vmcnt(0)
    s_barrier
    s_cmp_lg_u32 s8, 7
    s_cbranch_scc1 D_nf
    v_mov_b32 v4, 0
    s_mov_b64 exec, 1
    buffer_store_dwordx2 v[6:7], v4, s[4:7], s54 offen sc1
    s_mov_b64 exec, -1
D_nf:
    s_mov_b32 s50, 0
D_h_pl:
    buffer_load_dwordx2 v[8:9], v33, s[4:7], s11 offen sc1
    s_waitcnt vmcnt(0)
D_h_pc:
    v_cmp_ne_u64 vcc, s[48:49], v[8:9]
    s_add_u32 s50, s50, 1
    s_cmp_gt_u32 s50, 131072
    s_cbranch_scc1 D_h_pd
    s_cbranch_vccz D_h_pd
    s_sleep 8
    s_branch D_h_pl
D_h_pd:
    s_add_u32 m0, s27, 0
    buffer_load_dwordx4 v[104:107], v20, s[4:7], s28 offen sc1
    buffer_load_dwordx4 v22, s[12:15], s26 offen lds
    buffer_load_dwordx4 v23, s[12:15], s26 offen offset:1024 lds
    buffer_load_dwordx4 v[108:111], v21, s[4:7], s28 offen sc1
    s_add_u32 s30, s30, 1
    s_cmp_eq_u32 s30, 28
    s_cselect_b32 s9, -27, 1
    s_lshl_b32 s10, s9, 14
    s_add_u32 s26, s26, s10
    s_lshl_b32 s10, s9, 10
    s_add_u32 s28, s28, s10
    s_add_u32 m0, s27, 2048
    buffer_load_dwordx4 v[112:115], v20, s[4:7], s28 offen sc1
    buffer_load_dwordx4 v22, s[12:15], s26 offen lds
    buffer_load_dwordx4 v23, s[12:15], s26 offen offset:1024 lds
    buffer_load_dwordx4 v[116:119], v21, s[4:7], s28 offen sc1
    s_add_u32 s30, s30, 1
    s_cmp_eq_u32 s30, 28
    s_cselect_b32 s9, -27, 1
    s_lshl_b32 s10, s9, 14
    s_add_u32 s26, s26, s10
    s_lshl_b32 s10, s9, 10
    s_add_u32 s28, s28, s10
    s_mov_b32 s29, 0
D_loop:
    s_waitcnt vmcnt(4) lgkmcnt(0)
    ds_read_b64_tr_b16 v[168:169], v26 offset:0
    ds_read_b64_tr_b16 v[170:171], v26 offset:512
    ds_read_b64_tr_b16 v[172:173], v27 offset:0
    ds_read_b64_tr_b16 v[174:175], v27 offset:512
    v_mfma_f32_32x32x16_bf16 v[40:55], v[184:187], v[120:123], v[40:55]
    v_mfma_f32_32x32x16_bf16 v[56:71], v[188:191], v[120:123], v[56:71]
    v_mfma_f32_32x32x16_bf16 v[72:87], v[184:187], v[124:127], v[72:87]
    v_mfma_f32_32x32x16_bf16 v[88:103], v[188:191], v[124:127], v[88:103]
    s_add_u32 m0, s27, 4096
    buffer_load_dwordx4 v[120:123], v20, s[4:7], s28 offen sc1
    buffer_load_dwordx4 v22, s[12:15], s26 offen lds
    buffer_load_dwordx4 v23, s[12:15], s26 offen offset:1024 lds
    buffer_load_dwordx4 v[124:127], v21, s[4:7], s28 offen sc1
    s_add_u32 s30, s30, 1
    s_cmp_eq_u32 s30, 28
    s_cselect_b32 s9, -27, 1
    s_lshl_b32 s10, s9, 14
    s_add_u32 s26, s26, s10
    s_lshl_b32 s10, s9, 10
    s_add_u32 s28, s28, s10
    s_waitcnt vmcnt(4) lgkmcnt(0)
    ds_read_b64_tr_b16 v[176:177], v26 offset:2048
    ds_read_b64_tr_b16 v[178:179], v26 offset:2560
    ds_read_b64_tr_b16 v[180:181], v27 offset:2048
    ds_read_b64_tr_b16 v[182:183], v27 offset:2560
    v_mfma_f32_32x32x16_bf16 v[40:55], v[168:171], v[104:107], v[40:55]
    v_mfma_f32_32x32x16_bf16 v[56:71], v[172:175], v[104:107], v[56:71]
    v_mfma_f32_32x32x16_bf16 v[72:87], v[168:171], v[108:111], v[72:87]
    v_mfma_f32_32x32x16_bf16 v[88:103], v[172:175], v[108:111], v[88:103]
    s_cmp_eq_u32 s29, 9
    s_cbranch_scc1 D_done
    s_add_u32 m0, s27, 0
    buffer_load_dwordx4 v[104:107], v20, s[4:7], s28 offen sc1
    buffer_load_dwordx4 v22, s[12:15], s26 offen lds
    buffer_load_dwordx4 v23, s[12:15], s26 offen offset:1024 lds
    buffer_load_dwordx4 v[108:111], v21, s[4:7], s28 offen sc1
    s_add_u32 s30, s30, 1
    s_cmp_eq_u32 s30, 28
    s_cselect_b32 s9, -27, 1
    s_lshl_b32 s10, s9, 14
    s_add_u32 s26, s26, s10
    s_lshl_b32 s10, s9, 10
    s_add_u32 s28, s28, s10
    s_waitcnt vmcnt(4) lgkmcnt(0)
    ds_read_b64_tr_b16 v[184:185], v26 offset:4096
    ds_read_b64_tr_b16 v[186:187], v26 offset:4608
    ds_read_b64_tr_b16 v[188:189], v27 offset:4096
    ds_read_b64_tr_b16 v[190:191], v27 offset:4608
    v_mfma_f32_32x32x16_bf16 v[40:55], v[176:179], v[112:115], v[40:55]
    v_mfma_f32_32x32x16_bf16 v[56:71], v[180:183], v[112:115], v[56:71]
    v_mfma_f32_32x32x16_bf16 v[72:87], v[176:179], v[116:119], v[72:87]
    v_mfma_f32_32x32x16_bf16 v[88:103], v[180:183], v[116:119], v[88:103]
    s_cmp_eq_u32 s29, 8
    s_cselect_b32 s28, 1073741824, s28
    s_cselect_b32 s26, 1073741824, s26
    s_add_u32 m0, s27, 2048
    buffer_load_dwordx4 v[112:115], v20, s[4:7], s28 offen sc1
    buffer_load_dwordx4 v22, s[12:15], s26 offen lds
    buffer_load_dwordx4 v23, s[12:15], s26 offen offset:1024 lds
    buffer_load_dwordx4 v[116:119], v21, s[4:7], s28 offen sc1
    s_add_u32 s30, s30, 1
    s_cmp_eq_u32 s30, 28
    s_cselect_b32 s9, -27, 1
    s_lshl_b32 s10, s9, 14
    s_add_u32 s26, s26, s10
    s_lshl_b32 s10, s9, 10
    s_add_u32 s28, s28, s10
    s_add_u32 s29, s29, 1
    s_branch D_loop
D_done:
    s_setprio 2
    s_lshl_b32 s26, s3, 17
    s_lshl_b32 s10, s25, 7
    s_add_u32 s26, s26, s10
    v_lshrrev_b32 v5, 8, v32
    v_and_b32 v5, 0xfc, v5
    s_lshl_b32 s9, s24, 8
    s_add_u32 s9, s9, 15728640
    buffer_load_dword v28, v5, s[4:7], s9 offen sc1
    v_subrev_u32 v26, s27, v26
    s_and_b32 s9, s3, 1
    s_lshl_b32 s9, s9, 15
    v_add_u32 v26, s9, v26
    v_xor_b32 v27, 64, v26
    s_lshl_b32 s27, s3, 14
    v_mov_b32 v4, 155648
    s_mov_b32 s50, 0
D_pw:
    ds_read_b32 v5, v4
    s_add_u32 s50, s50, 1
    s_waitcnt lgkmcnt(0)
    v_readfirstlane_b32 s9, v5
    s_cmp_gt_u32 s50, 131072
    s_cbranch_scc1 D_pwd
    s_and_b32 s9, s9, 4
    s_cbranch_scc1 D_pwd
    s_sleep 16
    s_branch D_pw
D_pwd:
    s_add_u32 m0, s27, 0
    s_nop 0
    buffer_load_dwordx4 v22, s[20:23], s26 offen offset:0 lds
    buffer_load_dwordx4 v23, s[20:23], s26 offen offset:1024 lds
    buffer_load_dwordx4 v24, s[20:23], s26 offen offset:2048 lds
    buffer_load_dwordx4 v25, s[20:23], s26 offen offset:3072 lds
    s_add_u32 s26, s26, 32768
    s_add_u32 m0, s27, 4096
    s_nop 0
    buffer_load_dwordx4 v22, s[20:23], s26 offen offset:0 lds
    buffer_load_dwordx4 v23, s[20:23], s26 offen offset:1024 lds
    buffer_load_dwordx4 v24, s[20:23], s26 offen offset:2048 lds
    buffer_load_dwordx4 v25, s[20:23], s26 offen offset:3072 lds
    s_add_u32 s26, s26, 32768
    s_add_u32 m0, s27, 8192
    s_nop 0
    buffer_load_dwordx4 v22, s[20:23], s26 offen offset:0 lds
    buffer_load_dwordx4 v23, s[20:23], s26 offen offset:1024 lds
    buffer_load_dwordx4 v24, s[20:23], s26 offen offset:2048 lds
    buffer_load_dwordx4 v25, s[20:23], s26 offen offset:3072 lds
    s_add_u32 s26, s26, 32768
    s_add_u32 m0, s27, 12288
    s_nop 0
    buffer_load_dwordx4 v22, s[20:23], s26 offen offset:0 lds
    buffer_load_dwordx4 v23, s[20:23], s26 offen offset:1024 lds
    buffer_load_dwordx4 v24, s[20:23], s26 offen offset:2048 lds
    buffer_load_dwordx4 v25, s[20:23], s26 offen offset:3072 lds
    s_add_u32 s26, s26, 32768
    s_lshl_b32 s28, s24, 16
    s_lshl_b32 s9, s3, 14
    s_add_u32 s28, s28, s9
    s_add_u32 s28, s28, 6291456
    s_lshl_b32 s11, s24, 1
    s_and_b32 s9, s3, 1
    s_add_u32 s11, s11, s9
    s_lshl_b32 s11, s11, 11
    s_add_u32 s11, s11, 15859712
    s_xor_b32 s9, s3, 1
    s_mul_i32 s9, s9, 12288
    s_add_u32 s9, s9, 65536
    v_add_u32 v23, s9, v3
    s_xor_b32 s9, s3, 2
    s_mul_i32 s9, s9, 12288
    s_add_u32 s9, s9, 69632
    v_add_u32 v24, s9, v3
    s_xor_b32 s9, s3, 3
    s_mul_i32 s9, s9, 12288
    s_add_u32 s9, s9, 73728
    v_add_u32 v25, s9, v3
    s_mul_i32 s9, s3, 12288
    s_add_u32 s9, s9, 65536
    v_add_u32 v22, s9, v3
    v_lshl_add_u32 v20, v2, 12, v3
    v_add_u32 v20, 131072, v20
    v_xor_b32 v21, 4096, v20
    s_lshl_b32 s26, s24, 16
    s_lshl_b32 s10, s25, 7
    s_add_u32 s26, s26, s10
    s_waitcnt vmcnt(0) lgkmcnt(0)
    v_sub_f32 v30, 1.0, v28
    v_cvt_pk_bf16_f32 v30, v30, v30
    v_lshlrev_b32 v30, 16, v30
    v_mov_b32 v29, v28
    v_mov_b32 v31, v30
    v_mov_b32 v4, 155648
    s_mov_b32 s50, 0
D_px:
    ds_read_b32 v5, v4
    s_add_u32 s50, s50, 1
    s_waitcnt lgkmcnt(0)
    v_readfirstlane_b32 s9, v5
    s_cmp_gt_u32 s50, 131072
    s_cbranch_scc1 D_pxd
    s_and_b32 s9, s9, 262144
    s_cbranch_scc1 D_pxd
    s_sleep 4
    s_branch D_px
D_pxd:
    ds_write_b128 v23, v[56:59] offset:0
    ds_write_b128 v23, v[60:63] offset:1024
    ds_write_b128 v23, v[64:67] offset:2048
    ds_write_b128 v23, v[68:71] offset:3072
    ds_write_b128 v24, v[72:75] offset:0
    ds_write_b128 v24, v[76:79] offset:1024
    ds_write_b128 v24, v[80:83] offset:2048
    ds_write_b128 v24, v[84:87] offset:3072
    ds_write_b128 v25, v[88:91] offset:0
    ds_write_b128 v25, v[92:95] offset:1024
    ds_write_b128 v25, v[96:99] offset:2048
    ds_write_b128 v25, v[100:103] offset:3072
    s_waitcnt lgkmcnt(0)
    s_barrier
    buffer_load_dwordx2 v[8:9], v33, s[4:7], s11 offen sc1
    ds_read_b128 v[56:59], v22 offset:0
    ds_read_b128 v[60:63], v22 offset:1024
    ds_read_b128 v[64:67], v22 offset:2048
    ds_read_b128 v[68:71], v22 offset:3072
    ds_read_b128 v[72:75], v22 offset:4096
    ds_read_b128 v[76:79], v22 offset:5120
    ds_read_b128 v[80:83], v22 offset:6144
    ds_read_b128 v[84:87], v22 offset:7168
    ds_read_b128 v[88:91], v22 offset:8192
    ds_read_b128 v[92:95], v22 offset:9216
    ds_read_b128 v[96:99], v22 offset:10240
    ds_read_b128 v[100:103], v22 offset:11264
    s_waitcnt lgkmcnt(8)
    v_pk_add_f32 v[40:41], v[40:41], v[56:57]
    v_pk_add_f32 v[42:43], v[42:43], v[58:59]
    v_pk_add_f32 v[44:45], v[44:45], v[60:61]
    v_pk_add_f32 v[46:47], v[46:47], v[62:63]
    v_pk_add_f32 v[48:49], v[48:49], v[64:65]
    v_pk_add_f32 v[50:51], v[50:51], v[66:67]
    v_pk_add_f32 v[52:53], v[52:53], v[68:69]
    v_pk_add_f32 v[54:55], v[54:55], v[70:71]
    s_waitcnt lgkmcnt(0)
    v_pk_add_f32 v[72:73], v[72:73], v[88:89]
    v_pk_add_f32 v[74:75], v[74:75], v[90:91]
    v_pk_add_f32 v[76:77], v[76:77], v[92:93]
    v_pk_add_f32 v[78:79], v[78:79], v[94:95]
    v_pk_add_f32 v[80:81], v[80:81], v[96:97]
    v_pk_add_f32 v[82:83], v[82:83], v[98:99]
    v_pk_add_f32 v[84:85], v[84:85], v[100:101]
    v_pk_add_f32 v[86:87], v[86:87], v[102:103]
    ds_read_b64_tr_b16 v[168:169], v26 offset:0
    ds_read_b64_tr_b16 v[170:171], v26 offset:512
    ds_read_b64_tr_b16 v[172:173], v27 offset:0
    ds_read_b64_tr_b16 v[174:175], v27 offset:512
    ds_read_b64_tr_b16 v[176:177], v26 offset:2048
    ds_read_b64_tr_b16 v[178:179], v26 offset:2560
    ds_read_b64_tr_b16 v[180:181], v27 offset:2048
    ds_read_b64_tr_b16 v[182:183], v27 offset:2560
    s_mov_b32 s50, 0
    s_waitcnt vmcnt(0)
    s_branch D_o_pc
D_o_pl:
    buffer_load_dwordx2 v[8:9], v33, s[4:7], s11 offen sc1
    s_waitcnt vmcnt(0)
D_o_pc:
    v_cmp_ne_u64 vcc, s[48:49], v[8:9]
    s_add_u32 s50, s50, 1
    s_cmp_gt_u32 s50, 131072
    s_cbranch_scc1 D_o_pd
    s_cbranch_vccz D_o_pd
    s_branch D_o_pl
D_o_pd:
    buffer_load_dwordx4 v[104:107], v3, s[4:7], s28 offen offset:0 sc1
    buffer_load_dwordx4 v[108:111], v3, s[4:7], s28 offen offset:1024 sc1
    buffer_load_dwordx4 v[112:115], v3, s[4:7], s28 offen offset:2048 sc1
    buffer_load_dwordx4 v[116:119], v3, s[4:7], s28 offen offset:3072 sc1
    s_add_u32 s28, s28, 4096
    buffer_load_dwordx4 v[120:123], v3, s[4:7], s28 offen offset:0 sc1
    buffer_load_dwordx4 v[124:127], v3, s[4:7], s28 offen offset:1024 sc1
    buffer_load_dwordx4 v[128:131], v3, s[4:7], s28 offen offset:2048 sc1
    buffer_load_dwordx4 v[132:135], v3, s[4:7], s28 offen offset:3072 sc1
    s_add_u32 s28, s28, 4096
    buffer_load_dwordx4 v[136:139], v3, s[4:7], s28 offen offset:0 sc1
    buffer_load_dwordx4 v[140:143], v3, s[4:7], s28 offen offset:1024 sc1
    buffer_load_dwordx4 v[144:147], v3, s[4:7], s28 offen offset:2048 sc1
    buffer_load_dwordx4 v[148:151], v3, s[4:7], s28 offen offset:3072 sc1
    s_add_u32 s28, s28, 4096
    buffer_load_dwordx4 v[152:155], v3, s[4:7], s28 offen offset:0 sc1
    buffer_load_dwordx4 v[156:159], v3, s[4:7], s28 offen offset:1024 sc1
    buffer_load_dwordx4 v[160:163], v3, s[4:7], s28 offen offset:2048 sc1
    buffer_load_dwordx4 v[164:167], v3, s[4:7], s28 offen offset:3072 sc1
    v_pk_add_f32 v[40:41], v[40:41], v[72:73]
    v_pk_add_f32 v[42:43], v[42:43], v[74:75]
    v_pk_add_f32 v[44:45], v[44:45], v[76:77]
    v_pk_add_f32 v[46:47], v[46:47], v[78:79]
    v_pk_add_f32 v[48:49], v[48:49], v[80:81]
    v_pk_add_f32 v[50:51], v[50:51], v[82:83]
    v_pk_add_f32 v[52:53], v[52:53], v[84:85]
    v_pk_add_f32 v[54:55], v[54:55], v[86:87]
    v_pk_mul_f32 v[40:41], v[40:41], v[30:31]
    v_pk_mul_f32 v[42:43], v[42:43], v[30:31]
    v_pk_mul_f32 v[44:45], v[44:45], v[30:31]
    v_pk_mul_f32 v[46:47], v[46:47], v[30:31]
    v_pk_mul_f32 v[48:49], v[48:49], v[30:31]
    v_pk_mul_f32 v[50:51], v[50:51], v[30:31]
    v_pk_mul_f32 v[52:53], v[52:53], v[30:31]
    v_pk_mul_f32 v[54:55], v[54:55], v[30:31]
    ds_read_b64_tr_b16 v[184:185], v26 offset:4096
    ds_read_b64_tr_b16 v[186:187], v26 offset:4608
    ds_read_b64_tr_b16 v[188:189], v27 offset:4096
    ds_read_b64_tr_b16 v[190:191], v27 offset:4608
    s_waitcnt vmcnt(15) lgkmcnt(8)
    v_mfma_f32_32x32x16_bf16 v[192:207], v[168:171], v[104:107], 0
    v_mfma_f32_32x32x16_bf16 v[208:223], v[172:175], v[104:107], 0
    ds_read_b64_tr_b16 v[168:169], v26 offset:6144
    ds_read_b64_tr_b16 v[170:171], v26 offset:6656
    ds_read_b64_tr_b16 v[172:173], v27 offset:6144
    ds_read_b64_tr_b16 v[174:175], v27 offset:6656
    s_waitcnt vmcnt(14) lgkmcnt(8)
    v_mfma_f32_32x32x16_bf16 v[192:207], v[176:179], v[108:111], v[192:207]
    v_mfma_f32_32x32x16_bf16 v[208:223], v[180:183], v[108:111], v[208:223]
    ds_read_b64_tr_b16 v[176:177], v26 offset:8192
    ds_read_b64_tr_b16 v[178:179], v26 offset:8704
    ds_read_b64_tr_b16 v[180:181], v27 offset:8192
    ds_read_b64_tr_b16 v[182:183], v27 offset:8704
    s_waitcnt vmcnt(13) lgkmcnt(8)
    v_mfma_f32_32x32x16_bf16 v[192:207], v[184:187], v[112:115], v[192:207]
    v_mfma_f32_32x32x16_bf16 v[208:223], v[188:191], v[112:115], v[208:223]
    ds_read_b64_tr_b16 v[184:185], v26 offset:10240
    ds_read_b64_tr_b16 v[186:187], v26 offset:10752
    ds_read_b64_tr_b16 v[188:189], v27 offset:10240
    ds_read_b64_tr_b16 v[190:191], v27 offset:10752
    s_waitcnt vmcnt(12) lgkmcnt(8)
    v_mfma_f32_32x32x16_bf16 v[192:207], v[168:171], v[116:119], v[192:207]
    v_mfma_f32_32x32x16_bf16 v[208:223], v[172:175], v[116:119], v[208:223]
    ds_read_b64_tr_b16 v[168:169], v26 offset:12288
    ds_read_b64_tr_b16 v[170:171], v26 offset:12800
    ds_read_b64_tr_b16 v[172:173], v27 offset:12288
    ds_read_b64_tr_b16 v[174:175], v27 offset:12800
    s_waitcnt vmcnt(11) lgkmcnt(8)
    v_mfma_f32_32x32x16_bf16 v[192:207], v[176:179], v[120:123], v[192:207]
    v_mfma_f32_32x32x16_bf16 v[208:223], v[180:183], v[120:123], v[208:223]
    ds_read_b64_tr_b16 v[176:177], v26 offset:14336
    ds_read_b64_tr_b16 v[178:179], v26 offset:14848
    ds_read_b64_tr_b16 v[180:181], v27 offset:14336
    ds_read_b64_tr_b16 v[182:183], v27 offset:14848
    s_waitcnt vmcnt(10) lgkmcnt(8)
    v_mfma_f32_32x32x16_bf16 v[192:207], v[184:187], v[124:127], v[192:207]
    v_mfma_f32_32x32x16_bf16 v[208:223], v[188:191], v[124:127], v[208:223]
    ds_read_b64_tr_b16 v[184:185], v26 offset:16384
    ds_read_b64_tr_b16 v[186:187], v26 offset:16896
    ds_read_b64_tr_b16 v[188:189], v27 offset:16384
    ds_read_b64_tr_b16 v[190:191], v27 offset:16896
    s_waitcnt vmcnt(9) lgkmcnt(8)
    v_mfma_f32_32x32x16_bf16 v[192:207], v[168:171], v[128:131], v[192:207]
    v_mfma_f32_32x32x16_bf16 v[208:223], v[172:175], v[128:131], v[208:223]
    ds_read_b64_tr_b16 v[168:169], v26 offset:18432
    ds_read_b64_tr_b16 v[170:171], v26 offset:18944
    ds_read_b64_tr_b16 v[172:173], v27 offset:18432
    ds_read_b64_tr_b16 v[174:175], v27 offset:18944
    s_waitcnt vmcnt(8) lgkmcnt(8)
    v_mfma_f32_32x32x16_bf16 v[192:207], v[176:179], v[132:135], v[192:207]
    v_mfma_f32_32x32x16_bf16 v[208:223], v[180:183], v[132:135], v[208:223]
    ds_read_b64_tr_b16 v[176:177], v26 offset:20480
    ds_read_b64_tr_b16 v[178:179], v26 offset:20992
    ds_read_b64_tr_b16 v[180:181], v27 offset:20480
    ds_read_b64_tr_b16 v[182:183], v27 offset:20992
    s_waitcnt vmcnt(7) lgkmcnt(8)
    v_mfma_f32_32x32x16_bf16 v[192:207], v[184:187], v[136:139], v[192:207]
    v_mfma_f32_32x32x16_bf16 v[208:223], v[188:191], v[136:139], v[208:223]
    ds_read_b64_tr_b16 v[184:185], v26 offset:22528
    ds_read_b64_tr_b16 v[186:187], v26 offset:23040
    ds_read_b64_tr_b16 v[188:189], v27 offset:22528
    ds_read_b64_tr_b16 v[190:191], v27 offset:23040
    s_waitcnt vmcnt(6) lgkmcnt(8)
    v_mfma_f32_32x32x16_bf16 v[192:207], v[168:171], v[140:143], v[192:207]
    v_mfma_f32_32x32x16_bf16 v[208:223], v[172:175], v[140:143], v[208:223]
    ds_read_b64_tr_b16 v[168:169], v26 offset:24576
    ds_read_b64_tr_b16 v[170:171], v26 offset:25088
    ds_read_b64_tr_b16 v[172:173], v27 offset:24576
    ds_read_b64_tr_b16 v[174:175], v27 offset:25088
    s_waitcnt vmcnt(5) lgkmcnt(8)
    v_mfma_f32_32x32x16_bf16 v[192:207], v[176:179], v[144:147], v[192:207]
    v_mfma_f32_32x32x16_bf16 v[208:223], v[180:183], v[144:147], v[208:223]
    ds_read_b64_tr_b16 v[176:177], v26 offset:26624
    ds_read_b64_tr_b16 v[178:179], v26 offset:27136
    ds_read_b64_tr_b16 v[180:181], v27 offset:26624
    ds_read_b64_tr_b16 v[182:183], v27 offset:27136
    s_waitcnt vmcnt(4) lgkmcnt(8)
    v_mfma_f32_32x32x16_bf16 v[192:207], v[184:187], v[148:151], v[192:207]
    v_mfma_f32_32x32x16_bf16 v[208:223], v[188:191], v[148:151], v[208:223]
    ds_read_b64_tr_b16 v[184:185], v26 offset:28672
    ds_read_b64_tr_b16 v[186:187], v26 offset:29184
    ds_read_b64_tr_b16 v[188:189], v27 offset:28672
    ds_read_b64_tr_b16 v[190:191], v27 offset:29184
    s_waitcnt vmcnt(3) lgkmcnt(8)
    v_mfma_f32_32x32x16_bf16 v[192:207], v[168:171], v[152:155], v[192:207]
    v_mfma_f32_32x32x16_bf16 v[208:223], v[172:175], v[152:155], v[208:223]
    ds_read_b64_tr_b16 v[168:169], v26 offset:30720
    ds_read_b64_tr_b16 v[170:171], v26 offset:31232
    ds_read_b64_tr_b16 v[172:173], v27 offset:30720
    ds_read_b64_tr_b16 v[174:175], v27 offset:31232
    s_waitcnt vmcnt(2) lgkmcnt(8)
    v_mfma_f32_32x32x16_bf16 v[192:207], v[176:179], v[156:159], v[192:207]
    v_mfma_f32_32x32x16_bf16 v[208:223], v[180:183], v[156:159], v[208:223]
    s_waitcnt vmcnt(1) lgkmcnt(4)
    v_mfma_f32_32x32x16_bf16 v[192:207], v[184:187], v[160:163], v[192:207]
    v_mfma_f32_32x32x16_bf16 v[208:223], v[188:191], v[160:163], v[208:223]
    s_waitcnt vmcnt(0) lgkmcnt(0)
    v_mfma_f32_32x32x16_bf16 v[208:223], v[172:175], v[164:167], v[208:223]
    v_mfma_f32_32x32x16_bf16 v[192:207], v[168:171], v[164:167], v[192:207]
    s_nop 10
    ds_write_b128 v20, v[208:211] offset:0
    ds_write_b128 v20, v[212:215] offset:1024
    ds_write_b128 v20, v[216:219] offset:2048
    ds_write_b128 v20, v[220:223] offset:3072
    v_pk_fma_f32 v[40:41], v[192:193], v[28:29], v[40:41]
    v_pk_fma_f32 v[42:43], v[194:195], v[28:29], v[42:43]
    v_pk_fma_f32 v[44:45], v[196:197], v[28:29], v[44:45]
    v_pk_fma_f32 v[46:47], v[198:199], v[28:29], v[46:47]
    v_pk_fma_f32 v[48:49], v[200:201], v[28:29], v[48:49]
    v_pk_fma_f32 v[50:51], v[202:203], v[28:29], v[50:51]
    v_pk_fma_f32 v[52:53], v[204:205], v[28:29], v[52:53]
    v_pk_fma_f32 v[54:55], v[206:207], v[28:29], v[54:55]
    s_waitcnt lgkmcnt(0)
    s_barrier
    ds_read_b128 v[192:195], v21 offset:0
    ds_read_b128 v[196:199], v21 offset:1024
    ds_read_b128 v[200:203], v21 offset:2048
    ds_read_b128 v[204:207], v21 offset:3072
    s_waitcnt lgkmcnt(2)
    v_pk_fma_f32 v[40:41], v[192:193], v[28:29], v[40:41]
    v_pk_fma_f32 v[42:43], v[194:195], v[28:29], v[42:43]
    v_pk_fma_f32 v[44:45], v[196:197], v[28:29], v[44:45]
    v_pk_fma_f32 v[46:47], v[198:199], v[28:29], v[46:47]
    v_cvt_pk_bf16_f32 v56, v40, v41
    v_cvt_pk_bf16_f32 v57, v42, v43
    v_cvt_pk_bf16_f32 v58, v44, v45
    v_cvt_pk_bf16_f32 v59, v46, v47
    buffer_store_dwordx4 v[56:59], v32, s[16:19], s26 offen offset:0
    s_waitcnt lgkmcnt(0)
    v_pk_fma_f32 v[48:49], v[200:201], v[28:29], v[48:49]
    v_pk_fma_f32 v[50:51], v[202:203], v[28:29], v[50:51]
    v_pk_fma_f32 v[52:53], v[204:205], v[28:29], v[52:53]
    v_pk_fma_f32 v[54:55], v[206:207], v[28:29], v[54:55]
    v_cvt_pk_bf16_f32 v60, v48, v49
    v_cvt_pk_bf16_f32 v61, v50, v51
    v_cvt_pk_bf16_f32 v62, v52, v53
    v_cvt_pk_bf16_f32 v63, v54, v55
    buffer_store_dwordx4 v[60:63], v32, s[16:19], s26 offen offset:32
    s_endpgm
Ap_lm:
    s_waitcnt lgkmcnt(0)
    s_barrier
    v_mfma_f32_32x32x16_bf16 v[104:119], v[52:55], v[44:47], v[104:119]
    ds_read_b128 v[200:203], v12 offset:0
    ds_read_b64_tr_b16 v[216:217], v16 offset:0
    v_mfma_f32_32x32x16_bf16 v[136:151], v[52:55], v[48:51], v[136:151]
    ds_read_b64_tr_b16 v[218:219], v16 offset:512
    ds_read_b128 v[204:207], v12 offset:4096
    v_mfma_f32_32x32x16_bf16 v[120:135], v[56:59], v[44:47], v[120:135]
    ds_read_b64_tr_b16 v[220:221], v17 offset:0
    ds_read_b64_tr_b16 v[222:223], v17 offset:512
    v_mfma_f32_32x32x16_bf16 v[152:167], v[56:59], v[48:51], v[152:167]
    ds_read_b64_tr_b16 v[224:225], v18 offset:0
    ds_read_b64_tr_b16 v[226:227], v18 offset:512
    v_mfma_f32_32x32x16_bf16 v[168:183], v[60:63], v[44:47], v[168:183]
    ds_read_b128 v[24:27], v13 offset:0
    ds_read_b64_tr_b16 v[32:33], v16 offset:2048
    v_mfma_f32_32x32x16_bf16 v[184:199], v[60:63], v[48:51], v[184:199]
    ds_read_b64_tr_b16 v[34:35], v16 offset:2560
    ds_read_b128 v[28:31], v13 offset:4096
    v_mfma_f32_32x32x16_bf16 v[104:119], v[72:75], v[64:67], v[104:119]
    ds_read_b64_tr_b16 v[36:37], v17 offset:2048
    ds_read_b64_tr_b16 v[38:39], v17 offset:2560
    v_mfma_f32_32x32x16_bf16 v[136:151], v[72:75], v[68:71], v[136:151]
    ds_read_b64_tr_b16 v[40:41], v18 offset:2048
    ds_read_b64_tr_b16 v[42:43], v18 offset:2560
    v_mfma_f32_32x32x16_bf16 v[120:135], v[76:79], v[64:67], v[120:135]
    v_mfma_f32_32x32x16_bf16 v[152:167], v[76:79], v[68:71], v[152:167]
    v_mfma_f32_32x32x16_bf16 v[168:183], v[80:83], v[64:67], v[168:183]
    v_mfma_f32_32x32x16_bf16 v[184:199], v[80:83], v[68:71], v[184:199]
Ap_lm_in:
    s_waitcnt lgkmcnt(0)
    s_barrier
    v_mfma_f32_32x32x16_bf16 v[104:119], v[216:219], v[200:203], v[104:119]
    ds_read_b128 v[44:47], v14 offset:0
    ds_read_b64_tr_b16 v[52:53], v16 offset:12288
    v_mfma_f32_32x32x16_bf16 v[136:151], v[216:219], v[204:207], v[136:151]
    ds_read_b64_tr_b16 v[54:55], v16 offset:12800
    ds_read_b128 v[48:51], v14 offset:4096
    v_mfma_f32_32x32x16_bf16 v[120:135], v[220:223], v[200:203], v[120:135]
    ds_read_b64_tr_b16 v[56:57], v17 offset:12288
    ds_read_b64_tr_b16 v[58:59], v17 offset:12800
    v_mfma_f32_32x32x16_bf16 v[152:167], v[220:223], v[204:207], v[152:167]
    ds_read_b64_tr_b16 v[60:61], v18 offset:12288
    ds_read_b64_tr_b16 v[62:63], v18 offset:12800
    v_mfma_f32_32x32x16_bf16 v[168:183], v[224:227], v[200:203], v[168:183]
    ds_read_b128 v[64:67], v15 offset:0
    ds_read_b64_tr_b16 v[72:73], v16 offset:14336
    v_mfma_f32_32x32x16_bf16 v[184:199], v[224:227], v[204:207], v[184:199]
    ds_read_b64_tr_b16 v[74:75], v16 offset:14848
    ds_read_b128 v[68:71], v15 offset:4096
    v_mfma_f32_32x32x16_bf16 v[104:119], v[32:35], v[24:27], v[104:119]
    ds_read_b64_tr_b16 v[76:77], v17 offset:14336
    ds_read_b64_tr_b16 v[78:79], v17 offset:14848
    v_mfma_f32_32x32x16_bf16 v[136:151], v[32:35], v[28:31], v[136:151]
    ds_read_b64_tr_b16 v[80:81], v18 offset:14336
    ds_read_b64_tr_b16 v[82:83], v18 offset:14848
    v_mfma_f32_32x32x16_bf16 v[120:135], v[36:39], v[24:27], v[120:135]
    v_mfma_f32_32x32x16_bf16 v[152:167], v[36:39], v[28:31], v[152:167]
    v_mfma_f32_32x32x16_bf16 v[168:183], v[40:43], v[24:27], v[168:183]
    v_mfma_f32_32x32x16_bf16 v[184:199], v[40:43], v[28:31], v[184:199]
    s_waitcnt lgkmcnt(0)
    s_barrier
    v_mfma_f32_32x32x16_bf16 v[104:119], v[52:55], v[44:47], v[104:119]
    ds_read_b128 v[200:203], v12 offset:16384
    ds_read_b64_tr_b16 v[216:217], v16 offset:24576
    v_mfma_f32_32x32x16_bf16 v[136:151], v[52:55], v[48:51], v[136:151]
    ds_read_b64_tr_b16 v[218:219], v16 offset:25088
    ds_read_b128 v[204:207], v12 offset:20480
    v_mfma_f32_32x32x16_bf16 v[120:135], v[56:59], v[44:47], v[120:135]
    ds_read_b64_tr_b16 v[220:221], v17 offset:24576
    ds_read_b64_tr_b16 v[222:223], v17 offset:25088
    v_mfma_f32_32x32x16_bf16 v[152:167], v[56:59], v[48:51], v[152:167]
    ds_read_b64_tr_b16 v[224:225], v18 offset:24576
    ds_read_b64_tr_b16 v[226:227], v18 offset:25088
    v_mfma_f32_32x32x16_bf16 v[168:183], v[60:63], v[44:47], v[168:183]
    ds_read_b128 v[24:27], v13 offset:16384
    ds_read_b64_tr_b16 v[32:33], v16 offset:26624
    v_mfma_f32_32x32x16_bf16 v[184:199], v[60:63], v[48:51], v[184:199]
    ds_read_b64_tr_b16 v[34:35], v16 offset:27136
    ds_read_b128 v[28:31], v13 offset:20480
    v_mfma_f32_32x32x16_bf16 v[104:119], v[72:75], v[64:67], v[104:119]
    ds_read_b64_tr_b16 v[36:37], v17 offset:26624
    ds_read_b64_tr_b16 v[38:39], v17 offset:27136
    v_mfma_f32_32x32x16_bf16 v[136:151], v[72:75], v[68:71], v[136:151]
    ds_read_b64_tr_b16 v[40:41], v18 offset:26624
    ds_read_b64_tr_b16 v[42:43], v18 offset:27136
    v_mfma_f32_32x32x16_bf16 v[120:135], v[76:79], v[64:67], v[120:135]
    v_mfma_f32_32x32x16_bf16 v[152:167], v[76:79], v[68:71], v[152:167]
    v_mfma_f32_32x32x16_bf16 v[168:183], v[80:83], v[64:67], v[168:183]
    v_mfma_f32_32x32x16_bf16 v[184:199], v[80:83], v[68:71], v[184:199]
    s_waitcnt lgkmcnt(0)
    s_barrier
    v_mfma_f32_32x32x16_bf16 v[104:119], v[216:219], v[200:203], v[104:119]
    ds_read_b128 v[44:47], v14 offset:16384
    ds_read_b64_tr_b16 v[52:53], v16 offset:36864
    v_mfma_f32_32x32x16_bf16 v[136:151], v[216:219], v[204:207], v[136:151]
    ds_read_b64_tr_b16 v[54:55], v16 offset:37376
    ds_read_b128 v[48:51], v14 offset:20480
    v_mfma_f32_32x32x16_bf16 v[120:135], v[220:223], v[200:203], v[120:135]
    ds_read_b64_tr_b16 v[56:57], v17 offset:36864
    ds_read_b64_tr_b16 v[58:59], v17 offset:37376
    v_mfma_f32_32x32x16_bf16 v[152:167], v[220:223], v[204:207], v[152:167]
    ds_read_b64_tr_b16 v[60:61], v18 offset:36864
    ds_read_b64_tr_b16 v[62:63], v18 offset:37376
    v_mfma_f32_32x32x16_bf16 v[168:183], v[224:227], v[200:203], v[168:183]
    ds_read_b128 v[64:67], v15 offset:16384
    ds_read_b64_tr_b16 v[72:73], v16 offset:38912
    v_mfma_f32_32x32x16_bf16 v[184:199], v[224:227], v[204:207], v[184:199]
    ds_read_b64_tr_b16 v[74:75], v16 offset:39424
    ds_read_b128 v[68:71], v15 offset:20480
    v_mfma_f32_32x32x16_bf16 v[104:119], v[32:35], v[24:27], v[104:119]
    ds_read_b64_tr_b16 v[76:77], v17 offset:38912
    ds_read_b64_tr_b16 v[78:79], v17 offset:39424
    v_mfma_f32_32x32x16_bf16 v[136:151], v[32:35], v[28:31], v[136:151]
    ds_read_b64_tr_b16 v[80:81], v18 offset:38912
    ds_read_b64_tr_b16 v[82:83], v18 offset:39424
    v_mfma_f32_32x32x16_bf16 v[120:135], v[36:39], v[24:27], v[120:135]
    v_mfma_f32_32x32x16_bf16 v[152:167], v[36:39], v[28:31], v[152:167]
    s_cmp_eq_u32 s50, 2
    s_cselect_b32 s9, -2, 1
    s_lshl_b32 s9, s9, 15
    v_add_u32 v12, s9, v12
    v_add_u32 v13, s9, v13
    v_add_u32 v14, s9, v14
    v_add_u32 v15, s9, v15
    s_add_u32 s50, s50, 1
    s_cmp_lt_u32 s50, 4
    v_mfma_f32_32x32x16_bf16 v[168:183], v[40:43], v[24:27], v[168:183]
    v_mfma_f32_32x32x16_bf16 v[184:199], v[40:43], v[28:31], v[184:199]
    s_cbranch_scc1 Ap_lm
    s_waitcnt lgkmcnt(0)
    s_barrier
    v_mfma_f32_32x32x16_bf16 v[104:119], v[52:55], v[44:47], v[104:119]
    v_mfma_f32_32x32x16_bf16 v[136:151], v[52:55], v[48:51], v[136:151]
    v_mfma_f32_32x32x16_bf16 v[120:135], v[56:59], v[44:47], v[120:135]
    v_mfma_f32_32x32x16_bf16 v[152:167], v[56:59], v[48:51], v[152:167]
    v_mfma_f32_32x32x16_bf16 v[168:183], v[60:63], v[44:47], v[168:183]
    v_mfma_f32_32x32x16_bf16 v[184:199], v[60:63], v[48:51], v[184:199]
    v_mfma_f32_32x32x16_bf16 v[104:119], v[72:75], v[64:67], v[104:119]
    v_mfma_f32_32x32x16_bf16 v[136:151], v[72:75], v[68:71], v[136:151]
    v_mfma_f32_32x32x16_bf16 v[120:135], v[76:79], v[64:67], v[120:135]
    v_mfma_f32_32x32x16_bf16 v[152:167], v[76:79], v[68:71], v[152:167]
    v_mfma_f32_32x32x16_bf16 v[168:183], v[80:83], v[64:67], v[168:183]
    v_mfma_f32_32x32x16_bf16 v[184:199], v[80:83], v[68:71], v[184:199]
    v_mov_b32 v6, 0
    buffer_load_dwordx2 v[6:7], v6, s[44:47], 0 offen sc1
    v_mov_b32 v216, 0xc0135761
    v_mov_b32 v217, 0xc0135761
    s_nop 7
    s_barrier
    v_mul_f32 v168, s36, v168
    v_mul_f32 v169, s36, v169
    v_mul_f32 v170, s36, v170
    v_mul_f32 v171, s36, v171
    v_mul_f32 v172, s36, v172
    v_mul_f32 v173, s36, v173
    v_mul_f32 v174, s36, v174
    v_mul_f32 v175, s36, v175
    v_mul_f32 v176, s36, v176
    v_mul_f32 v177, s36, v177
    v_mul_f32 v178, s36, v178
    v_mul_f32 v179, s36, v179
    v_mul_f32 v180, s36, v180
    v_mul_f32 v181, s36, v181
    v_mul_f32 v182, s36, v182
    v_mul_f32 v183, s36, v183
    v_cvt_pk_bf16_f32 v168, v168, v169
    v_cvt_pk_bf16_f32 v169, v170, v171
    v_cvt_pk_bf16_f32 v170, v172, v173
    v_cvt_pk_bf16_f32 v171, v174, v175
    v_cvt_pk_bf16_f32 v172, v176, v177
    v_cvt_pk_bf16_f32 v173, v178, v179
    v_cvt_pk_bf16_f32 v174, v180, v181
    v_cvt_pk_bf16_f32 v175, v182, v183
    buffer_store_dwordx4 v[168:171], v19, s[4:7], s22 offen sc1
    buffer_store_dwordx4 v[172:175], v19, s[4:7], s23 offen sc1
    s_add_u32 s22, s22, s40
    s_add_u32 s23, s23, s40
    v_mul_f32 v184, s36, v184
    v_mul_f32 v185, s36, v185
    v_mul_f32 v186, s36, v186
    v_mul_f32 v187, s36, v187
    v_mul_f32 v188, s36, v188
    v_mul_f32 v189, s36, v189
    v_mul_f32 v190, s36, v190
    v_mul_f32 v191, s36, v191
    v_mul_f32 v192, s36, v192
    v_mul_f32 v193, s36, v193
    v_mul_f32 v194, s36, v194
    v_mul_f32 v195, s36, v195
    v_mul_f32 v196, s36, v196
    v_mul_f32 v197, s36, v197
    v_mul_f32 v198, s36, v198
    v_mul_f32 v199, s36, v199
    v_cvt_pk_bf16_f32 v184, v184, v185
    v_cvt_pk_bf16_f32 v185, v186, v187
    v_cvt_pk_bf16_f32 v186, v188, v189
    v_cvt_pk_bf16_f32 v187, v190, v191
    v_cvt_pk_bf16_f32 v188, v192, v193
    v_cvt_pk_bf16_f32 v189, v194, v195
    v_cvt_pk_bf16_f32 v190, v196, v197
    v_cvt_pk_bf16_f32 v191, v198, v199
    buffer_store_dwordx4 v[184:187], v19, s[4:7], s22 offen sc1
    buffer_store_dwordx4 v[188:191], v19, s[4:7], s23 offen sc1
    s_barrier
    v_mul_f32 v228, v104, v104
    v_mul_f32 v229, v105, v105
    v_fma_f32 v228, v228, s38, v216
    v_fma_f32 v229, v229, s38, v216
    v_mul_f32 v228, v228, v104
    v_mul_f32 v229, v229, v105
    v_exp_f32 v228, v228
    v_exp_f32 v229, v229
    v_mul_f32 v104, v104, v112
    v_mul_f32 v105, v105, v113
    v_add_f32 v228, 1.0, v228
    v_add_f32 v229, 1.0, v229
    v_rcp_f32 v228, v228
    v_rcp_f32 v229, v229
    s_nop 0
    v_mul_f32 v104, v104, v228
    v_mul_f32 v105, v105, v229
    v_cvt_pk_bf16_f32 v240, v104, v105
    v_mul_f32 v230, v106, v106
    v_mul_f32 v231, v107, v107
    v_fma_f32 v230, v230, s38, v216
    v_fma_f32 v231, v231, s38, v216
    v_mul_f32 v230, v230, v106
    v_mul_f32 v231, v231, v107
    v_exp_f32 v230, v230
    v_exp_f32 v231, v231
    v_mul_f32 v106, v106, v114
    v_mul_f32 v107, v107, v115
    v_add_f32 v230, 1.0, v230
    v_add_f32 v231, 1.0, v231
    v_rcp_f32 v230, v230
    v_rcp_f32 v231, v231
    s_nop 0
    v_mul_f32 v106, v106, v230
    v_mul_f32 v107, v107, v231
    v_cvt_pk_bf16_f32 v241, v106, v107
    s_barrier
    v_mul_f32 v232, v108, v108
    v_mul_f32 v233, v109, v109
    v_fma_f32 v232, v232, s38, v216
    v_fma_f32 v233, v233, s38, v216
    v_mul_f32 v232, v232, v108
    v_mul_f32 v233, v233, v109
    v_exp_f32 v232, v232
    v_exp_f32 v233, v233
    v_mul_f32 v108, v108, v116
    v_mul_f32 v109, v109, v117
    v_add_f32 v232, 1.0, v232
    v_add_f32 v233, 1.0, v233
    v_rcp_f32 v232, v232
    v_rcp_f32 v233, v233
    s_nop 0
    v_mul_f32 v108, v108, v232
    v_mul_f32 v109, v109, v233
    v_cvt_pk_bf16_f32 v242, v108, v109
    v_lshrrev_b32 v4, 3, v1
    v_lshl_add_u32 v5, v2, 4, v4
    v_lshlrev_b32 v200, 10, v5
    v_lshl_add_u32 v4, v2, 3, v4
    v_mul_u32_u24 v202, 3584, v4
    v_lshrrev_b32 v4, 4, v1
    v_xor_b32 v5, v4, v1
    v_and_b32 v5, 7, v5
    v_lshl_add_u32 v200, v5, 4, v200
    v_xor_b32 v201, 64, v200
    v_add_u32 v201, 7168, v201
    v_and_b32 v4, 1, v4
    v_lshlrev_b32 v5, 1, v4
    v_xor_b32 v5, v5, v1
    v_and_b32 v5, 7, v5
    v_lshl_add_u32 v202, v5, 4, v202
    v_xor_b32 v203, 64, v202
    s_barrier
    s_add_u32 s11, s51, s62
    s_add_u32 m0, s19, 32768
    s_nop 0
    buffer_load_dwordx4 v200, s[24:27], s11 offen offset:0 lds
    v_mul_f32 v234, v110, v110
    v_mul_f32 v235, v111, v111
    v_fma_f32 v234, v234, s38, v216
    v_fma_f32 v235, v235, s38, v216
    v_mul_f32 v234, v234, v110
    v_mul_f32 v235, v235, v111
    s_add_u32 m0, s18, 36864
    s_nop 0
    buffer_load_dwordx4 v202, s[28:31], s59 offen lds
    v_exp_f32 v234, v234
    v_exp_f32 v235, v235
    v_mul_f32 v110, v110, v118
    v_mul_f32 v111, v111, v119
    v_add_f32 v234, 1.0, v234
    v_add_f32 v235, 1.0, v235
    s_add_u32 m0, s18, 40960
    s_nop 0
    buffer_load_dwordx4 v203, s[32:35], s59 offen lds
    s_add_u32 s59, s59, s65
    s_sub_u32 s66, s59, 1835008
    s_cmp_ge_u32 s59, s61
    s_cselect_b32 s59, s66, s59
    s_add_u32 s62, s62, s64
    s_and_b32 s62, s62, 0x3ff
    v_rcp_f32 v234, v234
    v_rcp_f32 v235, v235
    s_nop 0
    v_mul_f32 v110, v110, v234
    v_mul_f32 v111, v111, v235
    v_cvt_pk_bf16_f32 v243, v110, v111
    s_barrier
    s_add_u32 m0, s19, 32768
    s_nop 0
    buffer_load_dwordx4 v201, s[24:27], s11 offen offset:1024 lds
    v_mul_f32 v228, v120, v120
    v_mul_f32 v229, v121, v121
    v_fma_f32 v228, v228, s38, v216
    v_fma_f32 v229, v229, s38, v216
    v_mul_f32 v228, v228, v120
    v_mul_f32 v229, v229, v121
    s_add_u32 m0, s18, 0
    s_nop 0
    buffer_load_dwordx4 v202, s[28:31], s59 offen lds
    v_exp_f32 v228, v228
    v_exp_f32 v229, v229
    v_mul_f32 v120, v120, v128
    v_mul_f32 v121, v121, v129
    v_add_f32 v228, 1.0, v228
    v_add_f32 v229, 1.0, v229
    s_add_u32 m0, s18, 4096
    s_nop 0
    buffer_load_dwordx4 v203, s[32:35], s59 offen lds
    s_add_u32 s59, s59, 114688
    v_rcp_f32 v228, v228
    v_rcp_f32 v229, v229
    s_nop 0
    v_mul_f32 v120, v120, v228
    v_mul_f32 v121, v121, v229
    v_cvt_pk_bf16_f32 v244, v120, v121
    s_barrier
    s_add_u32 s11, s11, 65536
    s_add_u32 m0, s19, 40960
    s_nop 0
    buffer_load_dwordx4 v200, s[24:27], s11 offen offset:0 lds
    v_mul_f32 v230, v122, v122
    v_mul_f32 v231, v123, v123
    v_fma_f32 v230, v230, s38, v216
    v_fma_f32 v231, v231, s38, v216
    v_mul_f32 v230, v230, v122
    v_mul_f32 v231, v231, v123
    s_add_u32 m0, s18, 12288
    s_nop 0
    buffer_load_dwordx4 v202, s[28:31], s59 offen lds
    v_exp_f32 v230, v230
    v_exp_f32 v231, v231
    v_mul_f32 v122, v122, v130
    v_mul_f32 v123, v123, v131
    v_add_f32 v230, 1.0, v230
    v_add_f32 v231, 1.0, v231
    s_add_u32 m0, s18, 16384
    s_nop 0
    buffer_load_dwordx4 v203, s[32:35], s59 offen lds
    s_add_u32 s59, s59, s65
    s_sub_u32 s66, s59, 1835008
    s_cmp_ge_u32 s59, s61
    s_cselect_b32 s59, s66, s59
    v_rcp_f32 v230, v230
    v_rcp_f32 v231, v231
    s_nop 0
    v_mul_f32 v122, v122, v230
    v_mul_f32 v123, v123, v231
    v_cvt_pk_bf16_f32 v245, v122, v123
    s_waitcnt vmcnt(6)
    s_mov_b32 s50, 0
Ap_m_tg:
    v_readfirstlane_b32 s48, v6
    v_readfirstlane_b32 s49, v7
    s_add_u32 s50, s50, 1
    s_cmp_lg_u64 s[48:49], 0
    s_cbranch_scc1 Ap_m_tgd
    s_cmp_gt_u32 s50, 131072
    s_cbranch_scc1 Ap_m_tgd
    s_sleep 4
    v_mov_b32 v6, 0
    buffer_load_dwordx2 v[6:7], v6, s[44:47], 0 offen sc1
    s_waitcnt vmcnt(0)
    s_branch Ap_m_tg
Ap_m_tgd:
    s_barrier
    s_cmp_lg_u32 s8, 3
    s_cbranch_scc1 Ap_m_nf
    v_mov_b32 v4, 0
    s_mov_b64 exec, 1
    buffer_store_dwordx2 v[6:7], v4, s[4:7], s54 offen sc1
    s_mov_b64 exec, -1
Ap_m_nf:
    s_add_u32 m0, s19, 40960
    s_nop 0
    buffer_load_dwordx4 v201, s[24:27], s11 offen offset:1024 lds
    v_mul_f32 v232, v124, v124
    v_mul_f32 v233, v125, v125
    v_fma_f32 v232, v232, s38, v216
    v_fma_f32 v233, v233, s38, v216
    v_mul_f32 v232, v232, v124
    v_mul_f32 v233, v233, v125
    s_add_u32 m0, s18, 24576
    s_nop 0
    buffer_load_dwordx4 v202, s[28:31], s59 offen lds
    v_exp_f32 v232, v232
    v_exp_f32 v233, v233
    v_mul_f32 v124, v124, v132
    v_mul_f32 v125, v125, v133
    v_add_f32 v232, 1.0, v232
    v_add_f32 v233, 1.0, v233
    s_add_u32 m0, s18, 28672
    s_nop 0
    buffer_load_dwordx4 v203, s[32:35], s59 offen lds
    s_add_u32 s59, s59, 114688
    v_rcp_f32 v232, v232
    v_rcp_f32 v233, v233
    s_nop 0
    v_mul_f32 v124, v124, v232
    v_mul_f32 v125, v125, v233
    v_cvt_pk_bf16_f32 v246, v124, v125
    s_waitcnt vmcnt(6)
    s_barrier
    s_add_u32 s11, s51, s62
    s_add_u32 m0, s19, 49152
    s_nop 0
    buffer_load_dwordx4 v200, s[24:27], s11 offen offset:0 lds
    v_mul_f32 v234, v126, v126
    v_mul_f32 v235, v127, v127
    v_fma_f32 v234, v234, s38, v216
    v_fma_f32 v235, v235, s38, v216
    v_mul_f32 v234, v234, v126
    v_mul_f32 v235, v235, v127
    s_add_u32 m0, s18, 36864
    s_nop 0
    buffer_load_dwordx4 v202, s[28:31], s59 offen lds
    v_exp_f32 v234, v234
    v_exp_f32 v235, v235
    v_mul_f32 v126, v126, v134
    v_mul_f32 v127, v127, v135
    v_add_f32 v234, 1.0, v234
    v_add_f32 v235, 1.0, v235
    s_add_u32 m0, s18, 40960
    s_nop 0
    buffer_load_dwordx4 v203, s[32:35], s59 offen lds
    s_add_u32 s59, s59, s65
    s_sub_u32 s66, s59, 1835008
    s_cmp_ge_u32 s59, s61
    s_cselect_b32 s59, s66, s59
    v_rcp_f32 v234, v234
    v_rcp_f32 v235, v235
    s_nop 0
    v_mul_f32 v126, v126, v234
    v_mul_f32 v127, v127, v235
    v_cvt_pk_bf16_f32 v247, v126, v127
    s_waitcnt vmcnt(6)
    s_barrier
    s_add_u32 m0, s19, 49152
    s_nop 0
    buffer_load_dwordx4 v201, s[24:27], s11 offen offset:1024 lds
    v_mul_f32 v228, v136, v136
    v_mul_f32 v229, v137, v137
    v_fma_f32 v228, v228, s38, v216
    v_fma_f32 v229, v229, s38, v216
    v_mul_f32 v228, v228, v136
    v_mul_f32 v229, v229, v137
    s_add_u32 m0, s18, 0
    s_nop 0
    buffer_load_dwordx4 v202, s[28:31], s59 offen lds
    v_exp_f32 v228, v228
    v_exp_f32 v229, v229
    v_mul_f32 v136, v136, v144
    v_mul_f32 v137, v137, v145
    v_add_f32 v228, 1.0, v228
    v_add_f32 v229, 1.0, v229
    s_add_u32 m0, s18, 4096
    s_nop 0
    buffer_load_dwordx4 v203, s[32:35], s59 offen lds
    s_add_u32 s59, s59, 114688
    v_rcp_f32 v228, v228
    v_rcp_f32 v229, v229
    s_nop 0
    v_mul_f32 v136, v136, v228
    v_mul_f32 v137, v137, v229
    v_cvt_pk_bf16_f32 v248, v136, v137
    s_waitcnt vmcnt(6)
    s_barrier
    s_add_u32 s11, s11, 65536
    s_add_u32 m0, s19, 57344
    s_nop 0
    buffer_load_dwordx4 v200, s[24:27], s11 offen offset:0 lds
    v_mul_f32 v230, v138, v138
    v_mul_f32 v231, v139, v139
    v_fma_f32 v230, v230, s38, v216
    v_fma_f32 v231, v231, s38, v216
    v_mul_f32 v230, v230, v138
    v_mul_f32 v231, v231, v139
    s_add_u32 m0, s18, 12288
    s_nop 0
    buffer_load_dwordx4 v202, s[28:31], s59 offen lds
    v_exp_f32 v230, v230
    v_exp_f32 v231, v231
    v_mul_f32 v138, v138, v146
    v_mul_f32 v139, v139, v147
    v_add_f32 v230, 1.0, v230
    v_add_f32 v231, 1.0, v231
    s_add_u32 m0, s18, 16384
    s_nop 0
    buffer_load_dwordx4 v203, s[32:35], s59 offen lds
    s_add_u32 s59, s59, s65
    s_sub_u32 s66, s59, 1835008
    s_cmp_ge_u32 s59, s61
    s_cselect_b32 s59, s66, s59
    v_rcp_f32 v230, v230
    v_rcp_f32 v231, v231
    s_nop 0
    v_mul_f32 v138, v138, v230
    v_mul_f32 v139, v139, v231
    v_cvt_pk_bf16_f32 v249, v138, v139
    s_waitcnt vmcnt(6)
    s_barrier
    s_add_u32 m0, s19, 57344
    s_nop 0
    buffer_load_dwordx4 v201, s[24:27], s11 offen offset:1024 lds
    v_mul_f32 v232, v140, v140
    v_mul_f32 v233, v141, v141
    v_fma_f32 v232, v232, s38, v216
    v_fma_f32 v233, v233, s38, v216
    v_mul_f32 v232, v232, v140
    v_mul_f32 v233, v233, v141
    s_add_u32 m0, s18, 24576
    s_nop 0
    buffer_load_dwordx4 v202, s[28:31], s59 offen lds
    v_exp_f32 v232, v232
    v_exp_f32 v233, v233
    v_mul_f32 v140, v140, v148
    v_mul_f32 v141, v141, v149
    v_add_f32 v232, 1.0, v232
    v_add_f32 v233, 1.0, v233
    s_add_u32 m0, s18, 28672
    s_nop 0
    buffer_load_dwordx4 v203, s[32:35], s59 offen lds
    s_add_u32 s59, s59, 114688
    v_rcp_f32 v232, v232
    v_rcp_f32 v233, v233
    s_nop 0
    v_mul_f32 v140, v140, v232
    v_mul_f32 v141, v141, v233
    v_cvt_pk_bf16_f32 v250, v140, v141
    s_waitcnt vmcnt(6)
    s_barrier
    s_add_u32 m0, s18, 36864
    s_nop 0
    buffer_load_dwordx4 v202, s[28:31], s59 offen lds
    v_mul_f32 v234, v142, v142
    v_mul_f32 v235, v143, v143
    v_fma_f32 v234, v234, s38, v216
    v_fma_f32 v235, v235, s38, v216
    v_mul_f32 v234, v234, v142
    v_mul_f32 v235, v235, v143
    v_exp_f32 v234, v234
    v_exp_f32 v235, v235
    v_mul_f32 v142, v142, v150
    s_add_u32 m0, s18, 40960
    s_nop 0
    buffer_load_dwordx4 v203, s[32:35], s59 offen lds
    v_mul_f32 v143, v143, v151
    v_add_f32 v234, 1.0, v234
    v_add_f32 v235, 1.0, v235
    v_rcp_f32 v234, v234
    v_rcp_f32 v235, v235
    s_nop 0
    v_mul_f32 v142, v142, v234
    v_mul_f32 v143, v143, v235
    v_cvt_pk_bf16_f32 v251, v142, v143
    buffer_load_dwordx2 v[8:9], v11, s[4:7], 0 offen sc1
    s_waitcnt vmcnt(6)
    s_barrier
    v_mul_f32 v228, v152, v152
    v_mul_f32 v229, v153, v153
    v_fma_f32 v228, v228, s38, v216
    v_fma_f32 v229, v229, s38, v216
    v_mul_f32 v228, v228, v152
    v_mul_f32 v229, v229, v153
    v_exp_f32 v228, v228
    v_exp_f32 v229, v229
    v_mul_f32 v152, v152, v160
    v_mul_f32 v153, v153, v161
    v_add_f32 v228, 1.0, v228
    v_add_f32 v229, 1.0, v229
    v_rcp_f32 v228, v228
    v_rcp_f32 v229, v229
    s_nop 0
    v_mul_f32 v152, v152, v228
    v_mul_f32 v153, v153, v229
    v_cvt_pk_bf16_f32 v252, v152, v153
    s_waitcnt vmcnt(3)
    s_barrier
    s_waitcnt vmcnt(0)
    v_cmp_ne_u64 vcc, s[48:49], v[8:9]
    s_mov_b32 m0, s56
    s_mov_b32 s41, 0
    s_cbranch_vccnz Ap_m_cn
    buffer_load_dwordx4 v10, s[4:7], s55 offen offset:0 sc1 lds
    buffer_load_dwordx4 v10, s[4:7], s55 offen offset:1024 sc1 lds
    buffer_load_dwordx4 v10, s[4:7], s55 offen offset:2048 sc1 lds
    buffer_load_dwordx4 v10, s[4:7], s55 offen offset:3072 sc1 lds
    buffer_load_dwordx4 v[12:15], v3, s[4:7], s13 offen sc1
    buffer_load_dwordx4 v[16:19], v3, s[4:7], s13 offen offset:1024 sc1
    s_mov_b32 s41, 1
    s_branch Ap_m_cy
Ap_m_cn:
    buffer_load_dwordx2 v[8:9], v11, s[4:7], 0 offen sc1
Ap_m_cy:
    v_mul_f32 v230, v154, v154
    v_mul_f32 v231, v155, v155
    v_fma_f32 v230, v230, s38, v216
    v_fma_f32 v231, v231, s38, v216
    v_mul_f32 v230, v230, v154
    v_mul_f32 v231, v231, v155
    v_exp_f32 v230, v230
    v_exp_f32 v231, v231
    v_mul_f32 v154, v154, v162
    v_mul_f32 v155, v155, v163
    v_add_f32 v230, 1.0, v230
    v_add_f32 v231, 1.0, v231
    v_rcp_f32 v230, v230
    v_rcp_f32 v231, v231
    s_nop 0
    v_mul_f32 v154, v154, v230
    v_mul_f32 v155, v155, v231
    v_cvt_pk_bf16_f32 v253, v154, v155
    v_mul_f32 v232, v156, v156
    v_mul_f32 v233, v157, v157
    v_fma_f32 v232, v232, s38, v216
    v_fma_f32 v233, v233, s38, v216
    v_mul_f32 v232, v232, v156
    v_mul_f32 v233, v233, v157
    v_exp_f32 v232, v232
    v_exp_f32 v233, v233
    v_mul_f32 v156, v156, v164
    v_mul_f32 v157, v157, v165
    v_add_f32 v232, 1.0, v232
    v_add_f32 v233, 1.0, v233
    v_rcp_f32 v232, v232
    v_rcp_f32 v233, v233
    s_nop 0
    v_mul_f32 v156, v156, v232
    v_mul_f32 v157, v157, v233
    v_cvt_pk_bf16_f32 v254, v156, v157
    s_barrier
    v_mul_f32 v234, v158, v158
    v_mul_f32 v235, v159, v159
    v_fma_f32 v234, v234, s38, v216
    v_fma_f32 v235, v235, s38, v216
    v_mul_f32 v234, v234, v158
    v_mul_f32 v235, v235, v159
    v_exp_f32 v234, v234
    v_exp_f32 v235, v235
    v_mul_f32 v158, v158, v166
    v_mul_f32 v159, v159, v167
    v_add_f32 v234, 1.0, v234
    v_add_f32 v235, 1.0, v235
    v_rcp_f32 v234, v234
    v_rcp_f32 v235, v235
    s_nop 0
    v_mul_f32 v158, v158, v234
    v_mul_f32 v159, v159, v235
    v_cvt_pk_bf16_f32 v255, v158, v159
    s_branch Ap_join
Ap_ls:
    s_waitcnt lgkmcnt(0)
    s_barrier
    v_mfma_f32_32x32x16_bf16 v[104:119], v[44:47], v[52:55], v[104:119]
    ds_read_b128 v[200:203], v12 offset:0
    ds_read_b64_tr_b16 v[216:217], v16 offset:0
    v_mfma_f32_32x32x16_bf16 v[136:151], v[48:51], v[52:55], v[136:151]
    ds_read_b64_tr_b16 v[218:219], v16 offset:512
    ds_read_b128 v[204:207], v12 offset:4096
    v_mfma_f32_32x32x16_bf16 v[120:135], v[44:47], v[56:59], v[120:135]
    ds_read_b64_tr_b16 v[220:221], v17 offset:0
    ds_read_b64_tr_b16 v[222:223], v17 offset:512
    v_mfma_f32_32x32x16_bf16 v[152:167], v[48:51], v[56:59], v[152:167]
    ds_read_b64_tr_b16 v[224:225], v18 offset:0
    ds_read_b64_tr_b16 v[226:227], v18 offset:512
    v_mfma_f32_32x32x16_bf16 v[168:183], v[60:63], v[44:47], v[168:183]
    ds_read_b128 v[24:27], v13 offset:0
    ds_read_b64_tr_b16 v[32:33], v16 offset:2048
    v_mfma_f32_32x32x16_bf16 v[184:199], v[60:63], v[48:51], v[184:199]
    ds_read_b64_tr_b16 v[34:35], v16 offset:2560
    ds_read_b128 v[28:31], v13 offset:4096
    v_mfma_f32_32x32x16_bf16 v[104:119], v[64:67], v[72:75], v[104:119]
    ds_read_b64_tr_b16 v[36:37], v17 offset:2048
    ds_read_b64_tr_b16 v[38:39], v17 offset:2560
    v_mfma_f32_32x32x16_bf16 v[136:151], v[68:71], v[72:75], v[136:151]
    ds_read_b64_tr_b16 v[40:41], v18 offset:2048
    ds_read_b64_tr_b16 v[42:43], v18 offset:2560
    v_mfma_f32_32x32x16_bf16 v[120:135], v[64:67], v[76:79], v[120:135]
    v_mfma_f32_32x32x16_bf16 v[152:167], v[68:71], v[76:79], v[152:167]
    v_mfma_f32_32x32x16_bf16 v[168:183], v[80:83], v[64:67], v[168:183]
    v_mfma_f32_32x32x16_bf16 v[184:199], v[80:83], v[68:71], v[184:199]
Ap_ls_in:
    s_waitcnt lgkmcnt(0)
    s_barrier
    v_mfma_f32_32x32x16_bf16 v[104:119], v[200:203], v[216:219], v[104:119]
    ds_read_b128 v[44:47], v14 offset:0
    ds_read_b64_tr_b16 v[52:53], v16 offset:12288
    v_mfma_f32_32x32x16_bf16 v[136:151], v[204:207], v[216:219], v[136:151]
    ds_read_b64_tr_b16 v[54:55], v16 offset:12800
    ds_read_b128 v[48:51], v14 offset:4096
    v_mfma_f32_32x32x16_bf16 v[120:135], v[200:203], v[220:223], v[120:135]
    ds_read_b64_tr_b16 v[56:57], v17 offset:12288
    ds_read_b64_tr_b16 v[58:59], v17 offset:12800
    v_mfma_f32_32x32x16_bf16 v[152:167], v[204:207], v[220:223], v[152:167]
    ds_read_b64_tr_b16 v[60:61], v18 offset:12288
    ds_read_b64_tr_b16 v[62:63], v18 offset:12800
    v_mfma_f32_32x32x16_bf16 v[168:183], v[224:227], v[200:203], v[168:183]
    ds_read_b128 v[64:67], v15 offset:0
    ds_read_b64_tr_b16 v[72:73], v16 offset:14336
    v_mfma_f32_32x32x16_bf16 v[184:199], v[224:227], v[204:207], v[184:199]
    ds_read_b64_tr_b16 v[74:75], v16 offset:14848
    ds_read_b128 v[68:71], v15 offset:4096
    v_mfma_f32_32x32x16_bf16 v[104:119], v[24:27], v[32:35], v[104:119]
    ds_read_b64_tr_b16 v[76:77], v17 offset:14336
    ds_read_b64_tr_b16 v[78:79], v17 offset:14848
    v_mfma_f32_32x32x16_bf16 v[136:151], v[28:31], v[32:35], v[136:151]
    ds_read_b64_tr_b16 v[80:81], v18 offset:14336
    ds_read_b64_tr_b16 v[82:83], v18 offset:14848
    v_mfma_f32_32x32x16_bf16 v[120:135], v[24:27], v[36:39], v[120:135]
    v_mfma_f32_32x32x16_bf16 v[152:167], v[28:31], v[36:39], v[152:167]
    v_mfma_f32_32x32x16_bf16 v[168:183], v[40:43], v[24:27], v[168:183]
    v_mfma_f32_32x32x16_bf16 v[184:199], v[40:43], v[28:31], v[184:199]
    s_waitcnt lgkmcnt(0)
    s_barrier
    v_mfma_f32_32x32x16_bf16 v[104:119], v[44:47], v[52:55], v[104:119]
    ds_read_b128 v[200:203], v12 offset:16384
    ds_read_b64_tr_b16 v[216:217], v16 offset:24576
    v_mfma_f32_32x32x16_bf16 v[136:151], v[48:51], v[52:55], v[136:151]
    ds_read_b64_tr_b16 v[218:219], v16 offset:25088
    ds_read_b128 v[204:207], v12 offset:20480
    v_mfma_f32_32x32x16_bf16 v[120:135], v[44:47], v[56:59], v[120:135]
    ds_read_b64_tr_b16 v[220:221], v17 offset:24576
    ds_read_b64_tr_b16 v[222:223], v17 offset:25088
    v_mfma_f32_32x32x16_bf16 v[152:167], v[48:51], v[56:59], v[152:167]
    ds_read_b64_tr_b16 v[224:225], v18 offset:24576
    ds_read_b64_tr_b16 v[226:227], v18 offset:25088
    v_mfma_f32_32x32x16_bf16 v[168:183], v[60:63], v[44:47], v[168:183]
    ds_read_b128 v[24:27], v13 offset:16384
    ds_read_b64_tr_b16 v[32:33], v16 offset:26624
    v_mfma_f32_32x32x16_bf16 v[184:199], v[60:63], v[48:51], v[184:199]
    ds_read_b64_tr_b16 v[34:35], v16 offset:27136
    ds_read_b128 v[28:31], v13 offset:20480
    v_mfma_f32_32x32x16_bf16 v[104:119], v[64:67], v[72:75], v[104:119]
    ds_read_b64_tr_b16 v[36:37], v17 offset:26624
    ds_read_b64_tr_b16 v[38:39], v17 offset:27136
    v_mfma_f32_32x32x16_bf16 v[136:151], v[68:71], v[72:75], v[136:151]
    ds_read_b64_tr_b16 v[40:41], v18 offset:26624
    ds_read_b64_tr_b16 v[42:43], v18 offset:27136
    v_mfma_f32_32x32x16_bf16 v[120:135], v[64:67], v[76:79], v[120:135]
    v_mfma_f32_32x32x16_bf16 v[152:167], v[68:71], v[76:79], v[152:167]
    v_mfma_f32_32x32x16_bf16 v[168:183], v[80:83], v[64:67], v[168:183]
    v_mfma_f32_32x32x16_bf16 v[184:199], v[80:83], v[68:71], v[184:199]
    s_waitcnt lgkmcnt(0)
    s_barrier
    v_mfma_f32_32x32x16_bf16 v[104:119], v[200:203], v[216:219], v[104:119]
    ds_read_b128 v[44:47], v14 offset:16384
    ds_read_b64_tr_b16 v[52:53], v16 offset:36864
    v_mfma_f32_32x32x16_bf16 v[136:151], v[204:207], v[216:219], v[136:151]
    ds_read_b64_tr_b16 v[54:55], v16 offset:37376
    ds_read_b128 v[48:51], v14 offset:20480
    v_mfma_f32_32x32x16_bf16 v[120:135], v[200:203], v[220:223], v[120:135]
    ds_read_b64_tr_b16 v[56:57], v17 offset:36864
    ds_read_b64_tr_b16 v[58:59], v17 offset:37376
    v_mfma_f32_32x32x16_bf16 v[152:167], v[204:207], v[220:223], v[152:167]
    ds_read_b64_tr_b16 v[60:61], v18 offset:36864
    ds_read_b64_tr_b16 v[62:63], v18 offset:37376
    v_mfma_f32_32x32x16_bf16 v[168:183], v[224:227], v[200:203], v[168:183]
    ds_read_b128 v[64:67], v15 offset:16384
    ds_read_b64_tr_b16 v[72:73], v16 offset:38912
    v_mfma_f32_32x32x16_bf16 v[184:199], v[224:227], v[204:207], v[184:199]
    ds_read_b64_tr_b16 v[74:75], v16 offset:39424
    ds_read_b128 v[68:71], v15 offset:20480
    v_mfma_f32_32x32x16_bf16 v[104:119], v[24:27], v[32:35], v[104:119]
    ds_read_b64_tr_b16 v[76:77], v17 offset:38912
    ds_read_b64_tr_b16 v[78:79], v17 offset:39424
    v_mfma_f32_32x32x16_bf16 v[136:151], v[28:31], v[32:35], v[136:151]
    ds_read_b64_tr_b16 v[80:81], v18 offset:38912
    ds_read_b64_tr_b16 v[82:83], v18 offset:39424
    v_mfma_f32_32x32x16_bf16 v[120:135], v[24:27], v[36:39], v[120:135]
    v_mfma_f32_32x32x16_bf16 v[152:167], v[28:31], v[36:39], v[152:167]
    s_cmp_eq_u32 s50, 2
    s_cselect_b32 s9, -2, 1
    s_lshl_b32 s9, s9, 15
    v_add_u32 v12, s9, v12
    v_add_u32 v13, s9, v13
    v_add_u32 v14, s9, v14
    v_add_u32 v15, s9, v15
    s_add_u32 s50, s50, 1
    s_cmp_lt_u32 s50, 4
    v_mfma_f32_32x32x16_bf16 v[168:183], v[40:43], v[24:27], v[168:183]
    v_mfma_f32_32x32x16_bf16 v[184:199], v[40:43], v[28:31], v[184:199]
    s_cbranch_scc1 Ap_ls
    s_waitcnt lgkmcnt(0)
    s_barrier
    v_mfma_f32_32x32x16_bf16 v[104:119], v[44:47], v[52:55], v[104:119]
    v_mfma_f32_32x32x16_bf16 v[136:151], v[48:51], v[52:55], v[136:151]
    v_mfma_f32_32x32x16_bf16 v[120:135], v[44:47], v[56:59], v[120:135]
    v_mfma_f32_32x32x16_bf16 v[152:167], v[48:51], v[56:59], v[152:167]
    v_mfma_f32_32x32x16_bf16 v[168:183], v[60:63], v[44:47], v[168:183]
    v_mfma_f32_32x32x16_bf16 v[184:199], v[60:63], v[48:51], v[184:199]
    v_mfma_f32_32x32x16_bf16 v[104:119], v[64:67], v[72:75], v[104:119]
    v_mfma_f32_32x32x16_bf16 v[136:151], v[68:71], v[72:75], v[136:151]
    v_mfma_f32_32x32x16_bf16 v[120:135], v[64:67], v[76:79], v[120:135]
    v_mfma_f32_32x32x16_bf16 v[152:167], v[68:71], v[76:79], v[152:167]
    v_mfma_f32_32x32x16_bf16 v[168:183], v[80:83], v[64:67], v[168:183]
    v_mfma_f32_32x32x16_bf16 v[184:199], v[80:83], v[68:71], v[184:199]
    v_mov_b32 v6, 0
    buffer_load_dwordx2 v[6:7], v6, s[44:47], 0 offen sc1
    s_nop 9
    v_cvt_pk_bf16_f32 v104, v104, v105
    v_cvt_pk_bf16_f32 v105, v106, v107
    v_cvt_pk_bf16_f32 v106, v108, v109
    v_cvt_pk_bf16_f32 v107, v110, v111
    v_cvt_pk_bf16_f32 v108, v112, v113
    v_cvt_pk_bf16_f32 v109, v114, v115
    v_cvt_pk_bf16_f32 v110, v116, v117
    v_cvt_pk_bf16_f32 v111, v118, v119
    buffer_store_dwordx4 v[104:107], v255, s[4:7], s42 offen offset:1024 sc1
    buffer_store_dwordx4 v[108:111], v255, s[4:7], s42 offen offset:1536 sc1
    v_cvt_pk_bf16_f32 v136, v136, v137
    v_cvt_pk_bf16_f32 v137, v138, v139
    v_cvt_pk_bf16_f32 v138, v140, v141
    v_cvt_pk_bf16_f32 v139, v142, v143
    v_cvt_pk_bf16_f32 v140, v144, v145
    v_cvt_pk_bf16_f32 v141, v146, v147
    v_cvt_pk_bf16_f32 v142, v148, v149
    v_cvt_pk_bf16_f32 v143, v150, v151
    buffer_store_dwordx4 v[136:139], v255, s[4:7], s42 offen offset:3072 sc1
    buffer_store_dwordx4 v[140:143], v255, s[4:7], s42 offen offset:3584 sc1
    v_cvt_pk_bf16_f32 v120, v120, v121
    v_cvt_pk_bf16_f32 v121, v122, v123
    v_cvt_pk_bf16_f32 v122, v124, v125
    v_cvt_pk_bf16_f32 v123, v126, v127
    v_cvt_pk_bf16_f32 v124, v128, v129
    v_cvt_pk_bf16_f32 v125, v130, v131
    v_cvt_pk_bf16_f32 v126, v132, v133
    v_cvt_pk_bf16_f32 v127, v134, v135
    buffer_store_dwordx4 v[120:123], v255, s[4:7], s43 offen offset:1024 sc1
    buffer_store_dwordx4 v[124:127], v255, s[4:7], s43 offen offset:1536 sc1
    s_barrier
    v_cvt_pk_bf16_f32 v152, v152, v153
    v_cvt_pk_bf16_f32 v153, v154, v155
    v_cvt_pk_bf16_f32 v154, v156, v157
    v_cvt_pk_bf16_f32 v155, v158, v159
    v_cvt_pk_bf16_f32 v156, v160, v161
    v_cvt_pk_bf16_f32 v157, v162, v163
    v_cvt_pk_bf16_f32 v158, v164, v165
    v_cvt_pk_bf16_f32 v159, v166, v167
    buffer_store_dwordx4 v[152:155], v255, s[4:7], s43 offen offset:3072 sc1
    buffer_store_dwordx4 v[156:159], v255, s[4:7], s43 offen offset:3584 sc1
    v_mul_f32 v168, s36, v168
    v_mul_f32 v169, s36, v169
    v_mul_f32 v170, s36, v170
    v_mul_f32 v171, s36, v171
    v_mul_f32 v172, s36, v172
    v_mul_f32 v173, s36, v173
    v_mul_f32 v174, s36, v174
    v_mul_f32 v175, s36, v175
    v_mul_f32 v176, s36, v176
    v_mul_f32 v177, s36, v177
    v_mul_f32 v178, s36, v178
    v_mul_f32 v179, s36, v179
    v_mul_f32 v180, s36, v180
    v_mul_f32 v181, s36, v181
    v_mul_f32 v182, s36, v182
    v_mul_f32 v183, s36, v183
    v_cvt_pk_bf16_f32 v168, v168, v169
    v_cvt_pk_bf16_f32 v169, v170, v171
    v_cvt_pk_bf16_f32 v170, v172, v173
    v_cvt_pk_bf16_f32 v171, v174, v175
    v_cvt_pk_bf16_f32 v172, v176, v177
    v_cvt_pk_bf16_f32 v173, v178, v179
    v_cvt_pk_bf16_f32 v174, v180, v181
    v_cvt_pk_bf16_f32 v175, v182, v183
    buffer_store_dwordx4 v[168:171], v19, s[4:7], s22 offen sc1
    buffer_store_dwordx4 v[172:175], v19, s[4:7], s23 offen sc1
    s_add_u32 s22, s22, s40
    s_add_u32 s23, s23, s40
    s_barrier
    v_mul_f32 v184, s36, v184
    v_mul_f32 v185, s36, v185
    v_mul_f32 v186, s36, v186
    v_mul_f32 v187, s36, v187
    v_mul_f32 v188, s36, v188
    v_mul_f32 v189, s36, v189
    v_mul_f32 v190, s36, v190
    v_mul_f32 v191, s36, v191
    v_mul_f32 v192, s36, v192
    v_mul_f32 v193, s36, v193
    v_mul_f32 v194, s36, v194
    v_mul_f32 v195, s36, v195
    v_mul_f32 v196, s36, v196
    v_mul_f32 v197, s36, v197
    v_mul_f32 v198, s36, v198
    v_mul_f32 v199, s36, v199
    v_cvt_pk_bf16_f32 v184, v184, v185
    v_cvt_pk_bf16_f32 v185, v186, v187
    v_cvt_pk_bf16_f32 v186, v188, v189
    v_cvt_pk_bf16_f32 v187, v190, v191
    v_cvt_pk_bf16_f32 v188, v192, v193
    v_cvt_pk_bf16_f32 v189, v194, v195
    v_cvt_pk_bf16_f32 v190, v196, v197
    v_cvt_pk_bf16_f32 v191, v198, v199
    buffer_store_dwordx4 v[184:187], v19, s[4:7], s22 offen sc1
    buffer_store_dwordx4 v[188:191], v19, s[4:7], s23 offen sc1
    s_barrier
    v_lshrrev_b32 v4, 3, v1
    v_lshl_add_u32 v5, v2, 4, v4
    v_lshlrev_b32 v200, 10, v5
    v_lshl_add_u32 v4, v2, 3, v4
    v_mul_u32_u24 v202, 3584, v4
    v_lshrrev_b32 v4, 4, v1
    v_xor_b32 v5, v4, v1
    v_and_b32 v5, 7, v5
    v_lshl_add_u32 v200, v5, 4, v200
    v_xor_b32 v201, 64, v200
    v_add_u32 v201, 7168, v201
    v_and_b32 v4, 1, v4
    v_lshlrev_b32 v5, 1, v4
    v_xor_b32 v5, v5, v1
    v_and_b32 v5, 7, v5
    v_lshl_add_u32 v202, v5, 4, v202
    v_xor_b32 v203, 64, v202
    s_barrier
    s_add_u32 s11, s51, s62
    s_add_u32 m0, s19, 32768
    s_nop 0
    buffer_load_dwordx4 v200, s[24:27], s11 offen offset:0 lds
    s_add_u32 m0, s18, 36864
    s_nop 0
    buffer_load_dwordx4 v202, s[28:31], s59 offen lds
    s_add_u32 m0, s18, 40960
    s_nop 0
    buffer_load_dwordx4 v203, s[32:35], s59 offen lds
    s_add_u32 s59, s59, s65
    s_sub_u32 s66, s59, 1835008
    s_cmp_ge_u32 s59, s61
    s_cselect_b32 s59, s66, s59
    s_add_u32 s62, s62, s64
    s_and_b32 s62, s62, 0x3ff
    s_barrier
    s_add_u32 m0, s19, 32768
    s_nop 0
    buffer_load_dwordx4 v201, s[24:27], s11 offen offset:1024 lds
    s_add_u32 m0, s18, 0
    s_nop 0
    buffer_load_dwordx4 v202, s[28:31], s59 offen lds
    s_add_u32 m0, s18, 4096
    s_nop 0
    buffer_load_dwordx4 v203, s[32:35], s59 offen lds
    s_add_u32 s59, s59, 114688
    s_barrier
    s_add_u32 s11, s11, 65536
    s_add_u32 m0, s19, 40960
    s_nop 0
    buffer_load_dwordx4 v200, s[24:27], s11 offen offset:0 lds
    s_add_u32 m0, s18, 12288
    s_nop 0
    buffer_load_dwordx4 v202, s[28:31], s59 offen lds
    s_add_u32 m0, s18, 16384
    s_nop 0
    buffer_load_dwordx4 v203, s[32:35], s59 offen lds
    s_add_u32 s59, s59, s65
    s_sub_u32 s66, s59, 1835008
    s_cmp_ge_u32 s59, s61
    s_cselect_b32 s59, s66, s59
    s_waitcnt vmcnt(6)
    s_mov_b32 s50, 0
Ap_s_tg:
    v_readfirstlane_b32 s48, v6
    v_readfirstlane_b32 s49, v7
    s_add_u32 s50, s50, 1
    s_cmp_lg_u64 s[48:49], 0
    s_cbranch_scc1 Ap_s_tgd
    s_cmp_gt_u32 s50, 131072
    s_cbranch_scc1 Ap_s_tgd
    s_sleep 4
    v_mov_b32 v6, 0
    buffer_load_dwordx2 v[6:7], v6, s[44:47], 0 offen sc1
    s_waitcnt vmcnt(0)
    s_branch Ap_s_tg
Ap_s_tgd:
    s_barrier
    s_cmp_lg_u32 s8, 3
    s_cbranch_scc1 Ap_s_nf
    v_mov_b32 v4, 0
    s_mov_b64 exec, 1
    buffer_store_dwordx2 v[6:7], v4, s[4:7], s54 offen sc1
    s_mov_b64 exec, -1
Ap_s_nf:
    s_add_u32 m0, s19, 40960
    s_nop 0
    buffer_load_dwordx4 v201, s[24:27], s11 offen offset:1024 lds
    s_add_u32 m0, s18, 24576
    s_nop 0
    buffer_load_dwordx4 v202, s[28:31], s59 offen lds
    s_add_u32 m0, s18, 28672
    s_nop 0
    buffer_load_dwordx4 v203, s[32:35], s59 offen lds
    s_add_u32 s59, s59, 114688
    s_waitcnt vmcnt(6)
    s_barrier
    s_add_u32 s11, s51, s62
    s_add_u32 m0, s19, 49152
    s_nop 0
    buffer_load_dwordx4 v200, s[24:27], s11 offen offset:0 lds
    s_add_u32 m0, s18, 36864
    s_nop 0
    buffer_load_dwordx4 v202, s[28:31], s59 offen lds
    s_add_u32 m0, s18, 40960
    s_nop 0
    buffer_load_dwordx4 v203, s[32:35], s59 offen lds
    s_add_u32 s59, s59, s65
    s_sub_u32 s66, s59, 1835008
    s_cmp_ge_u32 s59, s61
    s_cselect_b32 s59, s66, s59
    s_waitcnt vmcnt(6)
    s_barrier
    s_add_u32 m0, s19, 49152
    s_nop 0
    buffer_load_dwordx4 v201, s[24:27], s11 offen offset:1024 lds
    s_add_u32 m0, s18, 0
    s_nop 0
    buffer_load_dwordx4 v202, s[28:31], s59 offen lds
    s_add_u32 m0, s18, 4096
    s_nop 0
    buffer_load_dwordx4 v203, s[32:35], s59 offen lds
    s_add_u32 s59, s59, 114688
    s_waitcnt vmcnt(6)
    s_barrier
    s_add_u32 s11, s11, 65536
    s_add_u32 m0, s19, 57344
    s_nop 0
    buffer_load_dwordx4 v200, s[24:27], s11 offen offset:0 lds
    s_add_u32 m0, s18, 12288
    s_nop 0
    buffer_load_dwordx4 v202, s[28:31], s59 offen lds
    s_add_u32 m0, s18, 16384
    s_nop 0
    buffer_load_dwordx4 v203, s[32:35], s59 offen lds
    s_add_u32 s59, s59, s65
    s_sub_u32 s66, s59, 1835008
    s_cmp_ge_u32 s59, s61
    s_cselect_b32 s59, s66, s59
    s_waitcnt vmcnt(6)
    s_barrier
    s_add_u32 m0, s19, 57344
    s_nop 0
    buffer_load_dwordx4 v201, s[24:27], s11 offen offset:1024 lds
    s_add_u32 m0, s18, 24576
    s_nop 0
    buffer_load_dwordx4 v202, s[28:31], s59 offen lds
    s_add_u32 m0, s18, 28672
    s_nop 0
    buffer_load_dwordx4 v203, s[32:35], s59 offen lds
    s_add_u32 s59, s59, 114688
    s_waitcnt vmcnt(6)
    s_barrier
    s_add_u32 m0, s18, 36864
    s_nop 0
    buffer_load_dwordx4 v202, s[28:31], s59 offen lds
    s_add_u32 m0, s18, 40960
    s_nop 0
    buffer_load_dwordx4 v203, s[32:35], s59 offen lds
    buffer_load_dwordx2 v[8:9], v11, s[4:7], 0 offen sc1
    s_waitcnt vmcnt(6)
    s_barrier
    s_waitcnt vmcnt(3)
    s_barrier
    s_waitcnt vmcnt(0)
    v_cmp_ne_u64 vcc, s[48:49], v[8:9]
    s_mov_b32 m0, s56
    s_mov_b32 s41, 0
    s_cbranch_vccnz Ap_s_cn
    buffer_load_dwordx4 v10, s[4:7], s55 offen offset:0 sc1 lds
    buffer_load_dwordx4 v10, s[4:7], s55 offen offset:1024 sc1 lds
    buffer_load_dwordx4 v10, s[4:7], s55 offen offset:2048 sc1 lds
    buffer_load_dwordx4 v10, s[4:7], s55 offen offset:3072 sc1 lds
    buffer_load_dwordx4 v[12:15], v3, s[4:7], s13 offen sc1
    buffer_load_dwordx4 v[16:19], v3, s[4:7], s13 offen offset:1024 sc1
    s_mov_b32 s41, 1
    s_branch Ap_s_cy
Ap_s_cn:
    buffer_load_dwordx2 v[8:9], v11, s[4:7], 0 offen sc1
Ap_s_cy:
    s_barrier
    s_mov_b32 s57, 1073741824
    s_mov_b32 s58, 1073741824
Ap_join:
    s_cmp_lg_u32 s41, 0
    s_cbranch_scc1 Ap_rdy
    s_mov_b32 s50, 0
    s_waitcnt vmcnt(0)
    s_branch Ap_f1_pc
Ap_f1_pl:
    buffer_load_dwordx2 v[8:9], v11, s[4:7], 0 offen sc1
    s_waitcnt vmcnt(0)
Ap_f1_pc:
    v_cmp_ne_u64 vcc, s[48:49], v[8:9]
    s_add_u32 s50, s50, 1
    s_cmp_gt_u32 s50, 131072
    s_cbranch_scc1 Ap_f1_pd
    s_cbranch_vccz Ap_f1_pd
    s_branch Ap_f1_pl
Ap_f1_pd:
    buffer_load_dwordx4 v10, s[4:7], s55 offen offset:0 sc1 lds
    buffer_load_dwordx4 v10, s[4:7], s55 offen offset:1024 sc1 lds
    buffer_load_dwordx4 v10, s[4:7], s55 offen offset:2048 sc1 lds
    buffer_load_dwordx4 v10, s[4:7], s55 offen offset:3072 sc1 lds
    buffer_load_dwordx4 v[12:15], v3, s[4:7], s13 offen sc1
    buffer_load_dwordx4 v[16:19], v3, s[4:7], s13 offen offset:1024 sc1
Ap_rdy:
    s_mov_b32 s20, 0x0000ffff
    s_mov_b32 s21, 0x0000ffff
    v_mov_b32 v23, 0xdddddddd
    v_mov_b32 v21, v3
    v_and_b32 v4, 15, v1
    v_lshlrev_b32 v4, 4, v4
    v_lshrrev_b32 v5, 5, v1
    v_lshl_add_u32 v20, v5, 8, v4
    v_add_u32 v20, 1024, v20
    v_mov_b32 v22, v20
    v_and_b32 v4, 27, v1
    v_cmp_eq_u32 vcc, 16, v4
    v_mov_b32 v5, 0x3f803f80
    s_nop 0
    v_cndmask_b32 v4, 0, v5, vcc
    v_mov_b32 v5, v4
    v_mov_b64 v[160:161], 0
    v_mov_b64 v[162:163], 0
    s_nop 1
    v_mfma_f32_32x32x16_bf16 v[56:71], v[160:163], v[160:163], 0
    v_mfma_f32_32x32x16_bf16 v[72:87], v[160:163], v[160:163], 0
    v_mfma_f32_32x32x16_bf16 v[88:103], v[160:163], v[160:163], 0
    v_mov_b64 v[24:25], v[4:5]
    v_mov_b64 v[26:27], v[4:5]
    v_mov_b64 v[28:29], v[4:5]
    v_mov_b64 v[30:31], v[4:5]
    v_mov_b64 v[32:33], v[4:5]
    v_mov_b64 v[34:35], v[4:5]
    v_mov_b64 v[36:37], v[4:5]
    v_mov_b64 v[38:39], v[4:5]
    v_mov_b64 v[40:41], v[4:5]
    v_mov_b64 v[42:43], v[4:5]
    v_mov_b64 v[44:45], v[4:5]
    v_mov_b64 v[46:47], v[4:5]
    v_mov_b64 v[48:49], v[4:5]
    v_mov_b64 v[50:51], v[4:5]
    v_mov_b64 v[52:53], v[4:5]
    v_mov_b64 v[54:55], v[4:5]
    s_waitcnt vmcnt(0)
    s_barrier
    ds_read_b128 v[104:107], v21 offset:0
    ds_read_b128 v[108:111], v21 offset:2048
    s_mov_b64 exec, s[20:21]
    ds_read_b128 v[24:27], v22 offset:0
    ds_read_b128 v[28:31], v22 offset:512
    s_mov_b64 exec, -1
    s_mov_b64 exec, s[20:21]
    ds_read_b128 v[32:35], v22 offset:2048
    ds_read_b128 v[36:39], v22 offset:2560
    s_mov_b64 exec, -1
    s_waitcnt lgkmcnt(5)
    v_mfma_f32_32x32x16_bf16 v[112:127], v[104:107], v[12:15], 0
    v_mfma_f32_32x32x16_bf16 v[144:159], v[104:107], v[16:19], 0
    buffer_store_dwordx4 v[240:243], v3, s[4:7], s57 offen offset:0 sc1
    buffer_store_dwordx4 v[244:247], v3, s[4:7], s57 offen offset:1024 sc1
    buffer_store_dwordx4 v[248:251], v3, s[4:7], s58 offen offset:0 sc1
    buffer_store_dwordx4 v[252:255], v3, s[4:7], s58 offen offset:1024 sc1
    s_nop 6
    v_max3_f32 v4, v112, v113, v114
    v_max3_f32 v4, v115, v116, v4
    v_max3_f32 v4, v117, v118, v4
    v_max3_f32 v4, v119, v120, v4
    v_max3_f32 v4, v121, v122, v4
    v_max3_f32 v4, v123, v124, v4
    v_max3_f32 v4, v125, v126, v4
    v_max_f32 v4, v127, v4
    v_mov_b32 v5, v4
    s_nop 1
    v_permlane32_swap_b32 v4, v5
    s_nop 1
    v_max_f32 v4, v4, v5
    v_sub_f32 v160, 0, v4
    v_sub_f32 v161, 0, v4
    v_sub_f32 v162, 0, v4
    v_sub_f32 v163, 0, v4
    v_sub_f32 v164, 0, v4
    v_sub_f32 v165, 0, v4
    v_sub_f32 v166, 0, v4
    v_sub_f32 v167, 0, v4
    v_sub_f32 v168, 0, v4
    v_sub_f32 v169, 0, v4
    v_sub_f32 v170, 0, v4
    v_sub_f32 v171, 0, v4
    v_sub_f32 v172, 0, v4
    v_sub_f32 v173, 0, v4
    v_sub_f32 v174, 0, v4
    v_sub_f32 v175, 0, v4
    s_nop 1
    v_mfma_f32_32x32x16_bf16 v[112:127], v[104:107], v[12:15], v[160:175]
    v_max3_f32 v4, v144, v145, v146
    v_max3_f32 v4, v147, v148, v4
    v_max3_f32 v4, v149, v150, v4
    v_max3_f32 v4, v151, v152, v4
    v_max3_f32 v4, v153, v154, v4
    v_max3_f32 v4, v155, v156, v4
    v_max3_f32 v4, v157, v158, v4
    v_max_f32 v4, v159, v4
    v_mov_b32 v5, v4
    s_nop 1
    v_permlane32_swap_b32 v4, v5
    s_nop 1
    v_max_f32 v4, v4, v5
    v_sub_f32 v176, 0, v4
    v_sub_f32 v177, 0, v4
    v_sub_f32 v178, 0, v4
    v_sub_f32 v179, 0, v4
    v_sub_f32 v180, 0, v4
    v_sub_f32 v181, 0, v4
    v_sub_f32 v182, 0, v4
    v_sub_f32 v183, 0, v4
    v_sub_f32 v184, 0, v4
    v_sub_f32 v185, 0, v4
    v_sub_f32 v186, 0, v4
    v_sub_f32 v187, 0, v4
    v_sub_f32 v188, 0, v4
    v_sub_f32 v189, 0, v4
    v_sub_f32 v190, 0, v4
    v_sub_f32 v191, 0, v4
    s_mov_b32 s14, 0
    s_nop 0
    v_mfma_f32_32x32x16_bf16 v[144:159], v[104:107], v[16:19], v[176:191]
    s_branch A_mid
A_sp:
    s_cmp_ge_u32 s14, 4
    s_cbranch_scc1 A_pw
    s_cmp_eq_u32 s14, 1
    s_cbranch_scc1 A_b3
    s_waitcnt vmcnt(0)
A_b3:
    s_barrier
    s_branch A_go
A_pw:
    v_mov_b32 v4, 155648
    v_mov_b32 v5, 1
    s_waitcnt lgkmcnt(0)
    s_mov_b64 exec, 1
    ds_add_u32 v4, v5
    s_mov_b64 exec, -1
    s_branch A_go
A_top:
    v_add_u32 v21, 16384, v21
    v_add_u32 v22, 16384, v22
    s_bitcmp1_b32 22, s14
    s_cbranch_scc1 A_sp
A_go:
    v_smfmac_f32_32x32x32_bf16 v[72:87], v[32:35], v[88:95], v23
    s_waitcnt lgkmcnt(0)
    ds_read_b128 v[104:107], v21 offset:0
    v_exp_f32 v112, v112
    v_exp_f32 v113, v113
    v_exp_f32 v114, v114
    v_exp_f32 v115, v115
    v_exp_f32 v116, v116
    v_smfmac_f32_32x32x32_bf16 v[72:87], v[36:39], v[96:103], v23
    v_exp_f32 v117, v117
    v_exp_f32 v118, v118
    v_exp_f32 v119, v119
    v_exp_f32 v120, v120
    v_exp_f32 v121, v121
    v_mfma_f32_32x32x16_bf16 v[128:143], v[108:111], v[12:15], v[160:175]
    v_exp_f32 v122, v122
    v_exp_f32 v123, v123
    v_exp_f32 v124, v124
    v_exp_f32 v125, v125
    v_exp_f32 v126, v126
    v_exp_f32 v127, v127
    v_smfmac_f32_32x32x32_bf16 v[56:71], v[40:43], v[112:119], v23
    v_exp_f32 v144, v144
    v_exp_f32 v145, v145
    v_exp_f32 v146, v146
    v_exp_f32 v147, v147
    v_exp_f32 v148, v148
    v_smfmac_f32_32x32x32_bf16 v[56:71], v[44:47], v[120:127], v23
    s_mov_b64 exec, s[20:21]
    ds_read_b128 v[24:27], v22 offset:0
    ds_read_b128 v[28:31], v22 offset:512
    s_mov_b64 exec, -1
    v_exp_f32 v149, v149
    v_exp_f32 v150, v150
    v_exp_f32 v151, v151
    v_exp_f32 v152, v152
    v_exp_f32 v153, v153
    v_mfma_f32_32x32x16_bf16 v[88:103], v[108:111], v[16:19], v[176:191]
    v_exp_f32 v154, v154
    v_exp_f32 v155, v155
    v_exp_f32 v156, v156
    v_exp_f32 v157, v157
    v_exp_f32 v158, v158
    v_exp_f32 v159, v159
    v_smfmac_f32_32x32x32_bf16 v[72:87], v[40:43], v[144:151], v23
    s_waitcnt lgkmcnt(0)
    ds_read_b128 v[108:111], v21 offset:2048
    v_exp_f32 v128, v128
    v_exp_f32 v129, v129
    v_exp_f32 v130, v130
    v_exp_f32 v131, v131
    v_exp_f32 v132, v132
    v_smfmac_f32_32x32x32_bf16 v[72:87], v[44:47], v[152:159], v23
    v_exp_f32 v133, v133
    v_exp_f32 v134, v134
    v_exp_f32 v135, v135
    v_exp_f32 v136, v136
    v_exp_f32 v137, v137
    v_mfma_f32_32x32x16_bf16 v[112:127], v[104:107], v[12:15], v[160:175]
    v_exp_f32 v138, v138
    v_exp_f32 v139, v139
    v_exp_f32 v140, v140
    v_exp_f32 v141, v141
    v_exp_f32 v142, v142
    v_exp_f32 v143, v143
    v_smfmac_f32_32x32x32_bf16 v[56:71], v[48:51], v[128:135], v23
    v_exp_f32 v88, v88
    v_exp_f32 v89, v89
    v_exp_f32 v90, v90
    v_exp_f32 v91, v91
    v_exp_f32 v92, v92
    v_smfmac_f32_32x32x32_bf16 v[56:71], v[52:55], v[136:143], v23
    s_mov_b64 exec, s[20:21]
    ds_read_b128 v[32:35], v22 offset:2048
    ds_read_b128 v[36:39], v22 offset:2560
    s_mov_b64 exec, -1
    v_exp_f32 v93, v93
    v_exp_f32 v94, v94
    v_exp_f32 v95, v95
    v_exp_f32 v96, v96
    v_exp_f32 v97, v97
    v_mfma_f32_32x32x16_bf16 v[144:159], v[104:107], v[16:19], v[176:191]
    v_exp_f32 v98, v98
    v_exp_f32 v99, v99
    v_exp_f32 v100, v100
    v_exp_f32 v101, v101
    v_exp_f32 v102, v102
    v_exp_f32 v103, v103
    s_cmp_eq_u32 s14, 8
    s_cbranch_scc1 A_fin
A_mid:
    v_smfmac_f32_32x32x32_bf16 v[72:87], v[48:51], v[88:95], v23
    s_waitcnt lgkmcnt(0)
    ds_read_b128 v[104:107], v21 offset:4096
    v_exp_f32 v112, v112
    v_exp_f32 v113, v113
    v_exp_f32 v114, v114
    v_exp_f32 v115, v115
    v_exp_f32 v116, v116
    v_smfmac_f32_32x32x32_bf16 v[72:87], v[52:55], v[96:103], v23
    v_exp_f32 v117, v117
    v_exp_f32 v118, v118
    v_exp_f32 v119, v119
    v_exp_f32 v120, v120
    v_exp_f32 v121, v121
    v_mfma_f32_32x32x16_bf16 v[128:143], v[108:111], v[12:15], v[160:175]
    v_exp_f32 v122, v122
    v_exp_f32 v123, v123
    v_exp_f32 v124, v124
    v_exp_f32 v125, v125
    v_exp_f32 v126, v126
    v_exp_f32 v127, v127
    v_smfmac_f32_32x32x32_bf16 v[56:71], v[24:27], v[112:119], v23
    v_exp_f32 v144, v144
    v_exp_f32 v145, v145
    v_exp_f32 v146, v146
    v_exp_f32 v147, v147
    v_exp_f32 v148, v148
    v_smfmac_f32_32x32x32_bf16 v[56:71], v[28:31], v[120:127], v23
    s_mov_b64 exec, s[20:21]
    ds_read_b128 v[40:43], v22 offset:4096
    ds_read_b128 v[44:47], v22 offset:4608
    s_mov_b64 exec, -1
    v_exp_f32 v149, v149
    v_exp_f32 v150, v150
    v_exp_f32 v151, v151
    v_exp_f32 v152, v152
    v_exp_f32 v153, v153
    v_mfma_f32_32x32x16_bf16 v[88:103], v[108:111], v[16:19], v[176:191]
    v_exp_f32 v154, v154
    v_exp_f32 v155, v155
    v_exp_f32 v156, v156
    v_exp_f32 v157, v157
    v_exp_f32 v158, v158
    v_exp_f32 v159, v159
    v_smfmac_f32_32x32x32_bf16 v[72:87], v[24:27], v[144:151], v23
    s_waitcnt lgkmcnt(0)
    ds_read_b128 v[108:111], v21 offset:6144
    v_exp_f32 v128, v128
    v_exp_f32 v129, v129
    v_exp_f32 v130, v130
    v_exp_f32 v131, v131
    v_exp_f32 v132, v132
    v_smfmac_f32_32x32x32_bf16 v[72:87], v[28:31], v[152:159], v23
    v_exp_f32 v133, v133
    v_exp_f32 v134, v134
    v_exp_f32 v135, v135
    v_exp_f32 v136, v136
    v_exp_f32 v137, v137
    v_mfma_f32_32x32x16_bf16 v[112:127], v[104:107], v[12:15], v[160:175]
    v_exp_f32 v138, v138
    v_exp_f32 v139, v139
    v_exp_f32 v140, v140
    v_exp_f32 v141, v141
    v_exp_f32 v142, v142
    v_exp_f32 v143, v143
    v_smfmac_f32_32x32x32_bf16 v[56:71], v[32:35], v[128:135], v23
    v_exp_f32 v88, v88
    v_exp_f32 v89, v89
    v_exp_f32 v90, v90
    v_exp_f32 v91, v91
    v_exp_f32 v92, v92
    v_smfmac_f32_32x32x32_bf16 v[56:71], v[36:39], v[136:143], v23
    s_mov_b64 exec, s[20:21]
    ds_read_b128 v[48:51], v22 offset:6144
    ds_read_b128 v[52:55], v22 offset:6656
    s_mov_b64 exec, -1
    v_exp_f32 v93, v93
    v_exp_f32 v94, v94
    v_exp_f32 v95, v95
    v_exp_f32 v96, v96
    v_exp_f32 v97, v97
    v_mfma_f32_32x32x16_bf16 v[144:159], v[104:107], v[16:19], v[176:191]
    v_exp_f32 v98, v98
    v_exp_f32 v99, v99
    v_exp_f32 v100, v100
    v_exp_f32 v101, v101
    v_exp_f32 v102, v102
    v_exp_f32 v103, v103
    v_smfmac_f32_32x32x32_bf16 v[72:87], v[32:35], v[88:95], v23
    s_waitcnt lgkmcnt(0)
    ds_read_b128 v[104:107], v21 offset:8192
    v_exp_f32 v112, v112
    v_exp_f32 v113, v113
    v_exp_f32 v114, v114
    v_exp_f32 v115, v115
    v_exp_f32 v116, v116
    v_smfmac_f32_32x32x32_bf16 v[72:87], v[36:39], v[96:103], v23
    v_exp_f32 v117, v117
    v_exp_f32 v118, v118
    v_exp_f32 v119, v119
    v_exp_f32 v120, v120
    v_exp_f32 v121, v121
    v_mfma_f32_32x32x16_bf16 v[128:143], v[108:111], v[12:15], v[160:175]
    v_exp_f32 v122, v122
    v_exp_f32 v123, v123
    v_exp_f32 v124, v124
    v_exp_f32 v125, v125
    v_exp_f32 v126, v126
    v_exp_f32 v127, v127
    v_smfmac_f32_32x32x32_bf16 v[56:71], v[40:43], v[112:119], v23
    v_exp_f32 v144, v144
    v_exp_f32 v145, v145
    v_exp_f32 v146, v146
    v_exp_f32 v147, v147
    v_exp_f32 v148, v148
    v_smfmac_f32_32x32x32_bf16 v[56:71], v[44:47], v[120:127], v23
    s_mov_b64 exec, s[20:21]
    ds_read_b128 v[24:27], v22 offset:8192
    ds_read_b128 v[28:31], v22 offset:8704
    s_mov_b64 exec, -1
    v_exp_f32 v149, v149
    v_exp_f32 v150, v150
    v_exp_f32 v151, v151
    v_exp_f32 v152, v152
    v_exp_f32 v153, v153
    v_mfma_f32_32x32x16_bf16 v[88:103], v[108:111], v[16:19], v[176:191]
    v_exp_f32 v154, v154
    v_exp_f32 v155, v155
    v_exp_f32 v156, v156
    v_exp_f32 v157, v157
    v_exp_f32 v158, v158
    v_exp_f32 v159, v159
    v_smfmac_f32_32x32x32_bf16 v[72:87], v[40:43], v[144:151], v23
    s_waitcnt lgkmcnt(0)
    ds_read_b128 v[108:111], v21 offset:10240
    v_exp_f32 v128, v128
    v_exp_f32 v129, v129
    v_exp_f32 v130, v130
    v_exp_f32 v131, v131
    v_exp_f32 v132, v132
    v_smfmac_f32_32x32x32_bf16 v[72:87], v[44:47], v[152:159], v23
    v_exp_f32 v133, v133
    v_exp_f32 v134, v134
    v_exp_f32 v135, v135
    v_exp_f32 v136, v136
    v_exp_f32 v137, v137
    v_mfma_f32_32x32x16_bf16 v[112:127], v[104:107], v[12:15], v[160:175]
    v_exp_f32 v138, v138
    v_exp_f32 v139, v139
    v_exp_f32 v140, v140
    v_exp_f32 v141, v141
    v_exp_f32 v142, v142
    v_exp_f32 v143, v143
    v_smfmac_f32_32x32x32_bf16 v[56:71], v[48:51], v[128:135], v23
    v_exp_f32 v88, v88
    v_exp_f32 v89, v89
    v_exp_f32 v90, v90
    v_exp_f32 v91, v91
    v_exp_f32 v92, v92
    v_smfmac_f32_32x32x32_bf16 v[56:71], v[52:55], v[136:143], v23
    s_mov_b64 exec, s[20:21]
    ds_read_b128 v[32:35], v22 offset:10240
    ds_read_b128 v[36:39], v22 offset:10752
    s_mov_b64 exec, -1
    v_exp_f32 v93, v93
    v_exp_f32 v94, v94
    v_exp_f32 v95, v95
    v_exp_f32 v96, v96
    v_exp_f32 v97, v97
    v_mfma_f32_32x32x16_bf16 v[144:159], v[104:107], v[16:19], v[176:191]
    v_exp_f32 v98, v98
    v_exp_f32 v99, v99
    v_exp_f32 v100, v100
    v_exp_f32 v101, v101
    v_exp_f32 v102, v102
    v_exp_f32 v103, v103
    v_smfmac_f32_32x32x32_bf16 v[72:87], v[48:51], v[88:95], v23
    s_waitcnt lgkmcnt(0)
    ds_read_b128 v[104:107], v21 offset:12288
    v_exp_f32 v112, v112
    v_exp_f32 v113, v113
    v_exp_f32 v114, v114
    v_exp_f32 v115, v115
    v_exp_f32 v116, v116
    v_smfmac_f32_32x32x32_bf16 v[72:87], v[52:55], v[96:103], v23
    v_exp_f32 v117, v117
    v_exp_f32 v118, v118
    v_exp_f32 v119, v119
    v_exp_f32 v120, v120
    v_exp_f32 v121, v121
    v_mfma_f32_32x32x16_bf16 v[128:143], v[108:111], v[12:15], v[160:175]
    v_exp_f32 v122, v122
    v_exp_f32 v123, v123
    v_exp_f32 v124, v124
    v_exp_f32 v125, v125
    v_exp_f32 v126, v126
    v_exp_f32 v127, v127
    v_smfmac_f32_32x32x32_bf16 v[56:71], v[24:27], v[112:119], v23
    v_exp_f32 v144, v144
    v_exp_f32 v145, v145
    v_exp_f32 v146, v146
    v_exp_f32 v147, v147
    v_exp_f32 v148, v148
    v_smfmac_f32_32x32x32_bf16 v[56:71], v[28:31], v[120:127], v23
    s_mov_b64 exec, s[20:21]
    ds_read_b128 v[40:43], v22 offset:12288
    ds_read_b128 v[44:47], v22 offset:12800
    s_mov_b64 exec, -1
    v_exp_f32 v149, v149
    v_exp_f32 v150, v150
    v_exp_f32 v151, v151
    v_exp_f32 v152, v152
    v_exp_f32 v153, v153
    v_mfma_f32_32x32x16_bf16 v[88:103], v[108:111], v[16:19], v[176:191]
    v_exp_f32 v154, v154
    v_exp_f32 v155, v155
    v_exp_f32 v156, v156
    v_exp_f32 v157, v157
    v_exp_f32 v158, v158
    v_exp_f32 v159, v159
    v_smfmac_f32_32x32x32_bf16 v[72:87], v[24:27], v[144:151], v23
    s_waitcnt lgkmcnt(0)
    ds_read_b128 v[108:111], v21 offset:14336
    v_exp_f32 v128, v128
    v_exp_f32 v129, v129
    v_exp_f32 v130, v130
    v_exp_f32 v131, v131
    v_exp_f32 v132, v132
    v_smfmac_f32_32x32x32_bf16 v[72:87], v[28:31], v[152:159], v23
    v_exp_f32 v133, v133
    v_exp_f32 v134, v134
    v_exp_f32 v135, v135
    v_exp_f32 v136, v136
    v_exp_f32 v137, v137
    v_mfma_f32_32x32x16_bf16 v[112:127], v[104:107], v[12:15], v[160:175]
    v_exp_f32 v138, v138
    v_exp_f32 v139, v139
    v_exp_f32 v140, v140
    v_exp_f32 v141, v141
    v_exp_f32 v142, v142
    v_exp_f32 v143, v143
    v_smfmac_f32_32x32x32_bf16 v[56:71], v[32:35], v[128:135], v23
    v_exp_f32 v88, v88
    v_exp_f32 v89, v89
    v_exp_f32 v90, v90
    v_exp_f32 v91, v91
    v_exp_f32 v92, v92
    v_smfmac_f32_32x32x32_bf16 v[56:71], v[36:39], v[136:143], v23
    s_mov_b64 exec, s[20:21]
    ds_read_b128 v[48:51], v22 offset:14336
    ds_read_b128 v[52:55], v22 offset:14848
    s_mov_b64 exec, -1
    v_exp_f32 v93, v93
    v_exp_f32 v94, v94
    v_exp_f32 v95, v95
    v_exp_f32 v96, v96
    v_exp_f32 v97, v97
    v_mfma_f32_32x32x16_bf16 v[144:159], v[104:107], v[16:19], v[176:191]
    v_exp_f32 v98, v98
    v_exp_f32 v99, v99
    v_exp_f32 v100, v100
    v_exp_f32 v101, v101
    v_exp_f32 v102, v102
    v_exp_f32 v103, v103
    s_add_u32 s14, s14, 1
    s_branch A_top
A_fin:
    s_nop 1
    v_smfmac_f32_32x32x32_bf16 v[72:87], v[48:51], v[88:95], v23
    v_smfmac_f32_32x32x32_bf16 v[72:87], v[52:55], v[96:103], v23
    v_mov_b32 v4, 155648
    v_mov_b32 v5, 0x10000
    s_waitcnt lgkmcnt(0)
    s_mov_b64 exec, 1
    ds_add_u32 v4, v5
    s_mov_b64 exec, -1
    s_nop 7
    v_add_f32 v5, v64, v80
    v_fmac_f32 v5, 0, v56
    v_fmac_f32 v5, 0, v72
    v_fmac_f32 v5, 0, v57
    v_fmac_f32 v5, 0, v73
    v_fmac_f32 v5, 0, v58
    v_fmac_f32 v5, 0, v74
    v_fmac_f32 v5, 0, v59
    v_fmac_f32 v5, 0, v75
    v_fmac_f32 v5, 0, v60
    v_fmac_f32 v5, 0, v76
    v_fmac_f32 v5, 0, v61
    v_fmac_f32 v5, 0, v77
    v_fmac_f32 v5, 0, v62
    v_fmac_f32 v5, 0, v78
    v_fmac_f32 v5, 0, v63
    v_fmac_f32 v5, 0, v79
    v_cmp_nge_f32 vcc, 0x4e800000, v5
    s_add_u32 s9, s15, 32768
    s_cbranch_vccnz A_slow
A_out:
    v_rcp_f32 v4, v64
    s_nop 0
    v_mul_f32 v56, v56, v4
    v_mul_f32 v57, v57, v4
    v_mul_f32 v58, v58, v4
    v_mul_f32 v59, v59, v4
    v_mul_f32 v60, v60, v4
    v_mul_f32 v61, v61, v4
    v_mul_f32 v62, v62, v4
    v_mul_f32 v63, v63, v4
    v_cvt_pk_bf16_f32 v56, v56, v57
    v_cvt_pk_bf16_f32 v57, v58, v59
    v_cvt_pk_bf16_f32 v58, v60, v61
    v_cvt_pk_bf16_f32 v59, v62, v63
    buffer_store_dwordx4 v[56:59], v3, s[4:7], s15 offen sc1
    v_rcp_f32 v4, v80
    s_nop 0
    v_mul_f32 v72, v72, v4
    v_mul_f32 v73, v73, v4
    v_mul_f32 v74, v74, v4
    v_mul_f32 v75, v75, v4
    v_mul_f32 v76, v76, v4
    v_mul_f32 v77, v77, v4
    v_mul_f32 v78, v78, v4
    v_mul_f32 v79, v79, v4
    v_cvt_pk_bf16_f32 v72, v72, v73
    v_cvt_pk_bf16_f32 v73, v74, v75
    v_cvt_pk_bf16_f32 v74, v76, v77
    v_cvt_pk_bf16_f32 v75, v78, v79
    buffer_store_dwordx4 v[72:75], v3, s[4:7], s9 offen sc1
    s_waitcnt vmcnt(0)
    v_mov_b32 v4, 0
    s_mov_b64 exec, 1
    buffer_store_dwordx2 v[6:7], v4, s[4:7], s16 offen sc1
    s_mov_b64 exec, -1
    s_endpgm
A_slow:
    v_mov_b32 v160, 0xff800000
    v_mov_b32 v176, 0xff800000
    s_mov_b32 s17, s12
    s_mov_b32 s14, 0
A_fb1:
    buffer_load_dwordx4 v[104:107], v3, s[4:7], s17 offen sc1
    s_waitcnt vmcnt(0)
    v_mfma_f32_32x32x16_bf16 v[112:127], v[104:107], v[12:15], 0
    v_mfma_f32_32x32x16_bf16 v[144:159], v[104:107], v[16:19], 0
    s_nop 15
    v_max3_f32 v160, v112, v113, v160
    v_max3_f32 v160, v114, v115, v160
    v_max3_f32 v160, v116, v117, v160
    v_max3_f32 v160, v118, v119, v160
    v_max3_f32 v160, v120, v121, v160
    v_max3_f32 v160, v122, v123, v160
    v_max3_f32 v160, v124, v125, v160
    v_max3_f32 v160, v126, v127, v160
    v_max3_f32 v176, v144, v145, v176
    v_max3_f32 v176, v146, v147, v176
    v_max3_f32 v176, v148, v149, v176
    v_max3_f32 v176, v150, v151, v176
    v_max3_f32 v176, v152, v153, v176
    v_max3_f32 v176, v154, v155, v176
    v_max3_f32 v176, v156, v157, v176
    v_max3_f32 v176, v158, v159, v176
    s_add_u32 s17, s17, 2048
    s_add_u32 s14, s14, 1
    s_cmp_lt_u32 s14, 64
    s_cbranch_scc1 A_fb1
    v_mov_b32 v4, v160
    v_mov_b32 v5, v4
    s_nop 1
    v_permlane32_swap_b32 v4, v5
    s_nop 1
    v_max_f32 v4, v4, v5
    v_sub_f32 v160, 0, v4
    v_sub_f32 v161, 0, v4
    v_sub_f32 v162, 0, v4
    v_sub_f32 v163, 0, v4
    v_sub_f32 v164, 0, v4
    v_sub_f32 v165, 0, v4
    v_sub_f32 v166, 0, v4
    v_sub_f32 v167, 0, v4
    v_sub_f32 v168, 0, v4
    v_sub_f32 v169, 0, v4
    v_sub_f32 v170, 0, v4
    v_sub_f32 v171, 0, v4
    v_sub_f32 v172, 0, v4
    v_sub_f32 v173, 0, v4
    v_sub_f32 v174, 0, v4
    v_sub_f32 v175, 0, v4
    v_mov_b32 v4, v176
    v_mov_b32 v5, v4
    s_nop 1
    v_permlane32_swap_b32 v4, v5
    s_nop 1
    v_max_f32 v4, v4, v5
    v_sub_f32 v176, 0, v4
    v_sub_f32 v177, 0, v4
    v_sub_f32 v178, 0, v4
    v_sub_f32 v179, 0, v4
    v_sub_f32 v180, 0, v4
    v_sub_f32 v181, 0, v4
    v_sub_f32 v182, 0, v4
    v_sub_f32 v183, 0, v4
    v_sub_f32 v184, 0, v4
    v_sub_f32 v185, 0, v4
    v_sub_f32 v186, 0, v4
    v_sub_f32 v187, 0, v4
    v_sub_f32 v188, 0, v4
    v_sub_f32 v189, 0, v4
    v_sub_f32 v190, 0, v4
    v_sub_f32 v191, 0, v4
    v_mov_b32 v56, 0
    v_mov_b32 v72, 0
    v_mov_b32 v57, 0
    v_mov_b32 v73, 0
    v_mov_b32 v58, 0
    v_mov_b32 v74, 0
    v_mov_b32 v59, 0
    v_mov_b32 v75, 0
    v_mov_b32 v60, 0
    v_mov_b32 v76, 0
    v_mov_b32 v61, 0
    v_mov_b32 v77, 0
    v_mov_b32 v62, 0
    v_mov_b32 v78, 0
    v_mov_b32 v63, 0
    v_mov_b32 v79, 0
    v_mov_b32 v64, 0
    v_mov_b32 v80, 0
    v_mov_b32 v65, 0
    v_mov_b32 v81, 0
    v_mov_b32 v66, 0
    v_mov_b32 v82, 0
    v_mov_b32 v67, 0
    v_mov_b32 v83, 0
    v_mov_b32 v68, 0
    v_mov_b32 v84, 0
    v_mov_b32 v69, 0
    v_mov_b32 v85, 0
    v_mov_b32 v70, 0
    v_mov_b32 v86, 0
    v_mov_b32 v71, 0
    v_mov_b32 v87, 0
    s_mov_b32 s17, s12
    s_mov_b32 s14, 0
A_fb2:
    buffer_load_dwordx4 v[104:107], v3, s[4:7], s17 offen sc1
    s_mov_b64 exec, s[20:21]
    buffer_load_dwordx4 v[24:27], v20, s[4:7], s17 offen sc1
    buffer_load_dwordx4 v[28:31], v20, s[4:7], s17 offen offset:512 sc1
    s_mov_b64 exec, -1
    s_waitcnt vmcnt(0)
    v_mfma_f32_32x32x16_bf16 v[112:127], v[104:107], v[12:15], v[160:175]
    v_mfma_f32_32x32x16_bf16 v[144:159], v[104:107], v[16:19], v[176:191]
    s_nop 15
    v_exp_f32 v112, v112
    v_exp_f32 v113, v113
    v_exp_f32 v114, v114
    v_exp_f32 v115, v115
    v_exp_f32 v116, v116
    v_exp_f32 v117, v117
    v_exp_f32 v118, v118
    v_exp_f32 v119, v119
    v_exp_f32 v120, v120
    v_exp_f32 v121, v121
    v_exp_f32 v122, v122
    v_exp_f32 v123, v123
    v_exp_f32 v124, v124
    v_exp_f32 v125, v125
    v_exp_f32 v126, v126
    v_exp_f32 v127, v127
    v_exp_f32 v144, v144
    v_exp_f32 v145, v145
    v_exp_f32 v146, v146
    v_exp_f32 v147, v147
    v_exp_f32 v148, v148
    v_exp_f32 v149, v149
    v_exp_f32 v150, v150
    v_exp_f32 v151, v151
    v_exp_f32 v152, v152
    v_exp_f32 v153, v153
    v_exp_f32 v154, v154
    v_exp_f32 v155, v155
    v_exp_f32 v156, v156
    v_exp_f32 v157, v157
    v_exp_f32 v158, v158
    v_exp_f32 v159, v159
    s_nop 2
    v_smfmac_f32_32x32x32_bf16 v[56:71], v[24:27], v[112:119], v23
    v_smfmac_f32_32x32x32_bf16 v[56:71], v[28:31], v[120:127], v23
    v_smfmac_f32_32x32x32_bf16 v[72:87], v[24:27], v[144:151], v23
    v_smfmac_f32_32x32x32_bf16 v[72:87], v[28:31], v[152:159], v23
    s_add_u32 s17, s17, 2048
    s_add_u32 s14, s14, 1
    s_cmp_lt_u32 s14, 64
    s_cbranch_scc1 A_fb2
    s_nop 15
    s_branch A_out
L_end:
    s_endpgm
.section .rodata,"a"
.p2align 6
.amdhsa_kernel gated_mix__softmax_full_mha__geglu_ffn__prompt_kernel
  .amdhsa_next_free_vgpr 256
  .amdhsa_next_free_sgpr 100
  .amdhsa_accum_offset 256
  .amdhsa_group_segment_fixed_size 0
  .amdhsa_kernarg_size 88
  .amdhsa_user_sgpr_count 2
  .amdhsa_user_sgpr_kernarg_segment_ptr 1
  .amdhsa_system_sgpr_workgroup_id_x 1
.end_amdhsa_kernel
```
